```python
import torch

def _softmax(x, axis=-1):
    return torch.softmax(x, dim=axis)
def _gelu(x):
    return torch.nn.functional.gelu(x, approximate="tanh")
def _silu(x):
    return torch.nn.functional.silu(x)
def _sigmoid(x):
    return torch.sigmoid(x)
def _layernorm(x, axis=-1, eps=1e-5):
    m = x.mean(dim=axis, keepdim=True)
    v = x.var(dim=axis, keepdim=True, unbiased=False)
    return (x - m) / torch.sqrt(v + eps)
def _scatter_add(tgt, idx, src, axis=0):
    return tgt.clone().index_add_(axis, idx, src)
def _segment_sum(src, seg, n):
    out = torch.zeros((n,) + src.shape[1:], dtype=src.dtype)
    return out.index_add_(0, seg, src)
def _pad(x, pw):
    flat = tuple(v for pair in reversed(pw) for v in pair)
    return torch.nn.functional.pad(x, flat)

kernel_name = 'parallel_sum__sliding_block__dense_activation_relu__prompt'

def setup_inputs():

    _w = (lambda a: (lambda t: t.to(torch.bfloat16) if t.is_floating_point() else t)(torch.as_tensor(a)))
    def _A_setup():
        B, S, D = 1, 2048, 512
        return {
            "x": _w((lambda *s: torch.randn(*s, dtype=torch.bfloat16) * 0.05)(B, S, D)),
            "wqkv": _w((lambda *s: torch.randn(*s, dtype=torch.bfloat16) * 0.05)(D, 3 * D)),
            "wo": _w((lambda *s: torch.randn(*s, dtype=torch.bfloat16) * 0.1)(D, D)),
        }
    _A_in = _A_setup()

    def _B_setup():
        B, S, D, Dff = 1, 2048, 512, 1792
        return {
            "x": _w((lambda *s: torch.randn(*s, dtype=torch.bfloat16) * 0.05)(B, S, D)),
            "w1": _w((lambda *s: torch.randn(*s, dtype=torch.bfloat16) * 0.05)(D, Dff)),
            "w2": _w((lambda *s: torch.randn(*s, dtype=torch.bfloat16) * 0.05)(Dff, D)),
        }
    _B_in = _B_setup()

    return {
        "A_x": _A_in["x"],
        "A_wqkv": _A_in["wqkv"],
        "A_wo": _A_in["wo"],
        "B_x": _B_in["x"],
        "B_w1": _B_in["w1"],
        "B_w2": _B_in["w2"],
    }

def reference(A_x, A_wqkv, A_wo, B_x, B_w1, B_w2):
    def _A_ref(x, wqkv, wo):
        B, S, D = x.shape
        H = 32; Dh = D // H; W = 256
        qkv = (lambda x, *d: x.permute(*d))((x @ wqkv).reshape(B, S, 3, H, Dh), 2, 0, 3, 1, 4)
        q, k, v = qkv[0], qkv[1], qkv[2]
        scores = torch.einsum("bhqd,bhkd->bhqk", q, k) * (Dh ** -0.5)
        idx = torch.arange(S)
        mask = (idx[:, None] - idx[None, :] >= 0) & (idx[:, None] - idx[None, :] < W)
        scores = torch.where(mask[None, None], scores, -1e9)
        p = _softmax(scores, axis=-1)
        o = torch.einsum("bhqk,bhkd->bhqd", p, v)
        return (lambda x, *d: x.permute(*d))(o, 0, 2, 1, 3).reshape(B, S, D) @ wo

    def _B_ref(x, w1, w2):
        h = torch.einsum("bsd,df->bsf", x, w1)
        zero = torch.zeros_like(h)
        h = torch.maximum(h, zero)
        return torch.einsum("bsf,fd->bsd", h, w2)

    x = A_x
    xn = _layernorm(x, axis=-1)
    return x + _A_ref(xn, A_wqkv, A_wo) + _B_ref(xn, B_w1, B_w2)
```

```asm
; @launch grid=(256,1,1) block=(512,1,1) lds=163840
.amdgcn_target "amdgcn-amd-amdhsa--gfx950"
.text
.globl parallel_sum__sliding_block__dense_activation_relu__prompt_kernel
.p2align 8
.type parallel_sum__sliding_block__dense_activation_relu__prompt_kernel,@function
parallel_sum__sliding_block__dense_activation_relu__prompt_kernel:
    s_cmp_ge_u32 s2, 256
    s_cbranch_scc1 L_END
    s_load_dwordx16 s[4:19], s[0:1], 0
    s_load_dwordx2 s[20:21], s[0:1], 64
    v_lshrrev_b32 v1, 6, v0
    v_and_b32 v0, 63, v0
    v_readfirstlane_b32 s56, v1
    s_and_b32 s64, s2, 7
    s_lshr_b32 s65, s2, 3
    s_lshr_b32 s57, s64, 2
    s_lshl_b32 s57, s57, 3
    s_and_b32 s66, s65, 7
    s_add_u32 s57, s57, s66
    s_and_b32 s58, s64, 3
    s_lshl_b32 s58, s58, 2
    s_lshr_b32 s66, s65, 3
    s_lshl_b32 s66, s66, 2
    s_lshr_b32 s66, 12816, s66
    s_and_b32 s66, s66, 3
    s_add_u32 s58, s58, s66
    s_lshr_b32 s59, s58, 1
    s_and_b32 s62, s56, 3
    s_cmp_lt_u32 s56, 4
    s_cbranch_scc1 L_M
    s_lshl1_add_u32 s99, s58, s57
    s_and_b32 s99, s99, 7
    v_mov_b32 v7, 0
    s_cmp_ge_u32 s62, 2
    s_cbranch_scc1 L_hB_158
    v_and_b32 v2, 7, v0
    v_lshrrev_b32 v18, 4, v0
    v_xor_b32 v2, v2, v18
    v_lshlrev_b32 v2, 4, v2
    v_lshrrev_b32 v18, 3, v0
    v_lshl_add_u32 v2, v18, 10, v2
    v_xor_b32 v3, 64, v2
    v_lshrrev_b32 v4, 2, v0
    v_mul_u32_u24 v4, 3072, v4
    v_and_b32 v18, 3, v0
    v_lshl_add_u32 v4, v18, 4, v4
    s_lshl_b32 s68, s57, 17
    s_lshl_b32 s64, s62, 16
    s_add_u32 s68, s68, s64
    s_mul_i32 s69, s62, 98304
    s_lshl_b32 s64, s58, 6
    s_add_u32 s69, s69, s64
    s_lshl_b32 s74, s62, 13
    s_lshl_b32 s75, s62, 11
    s_waitcnt lgkmcnt(0)
    s_mov_b32 s24, s4
    s_and_b32 s25, s5, 0xffff
    s_mov_b32 s26, 2097152
    s_mov_b32 s27, 0x20000
    s_mov_b32 s28, s6
    s_and_b32 s29, s7, 0xffff
    s_mov_b32 s30, 1572864
    s_mov_b32 s31, 0x20000
    s_add_u32 s78, s99, 0
    s_and_b32 s78, s78, 7
    s_lshl_b32 s77, s78, 7
    s_add_u32 s77, s77, s68
    s_mul_i32 s78, s78, 196608
    s_add_u32 s78, s78, s69
    s_add_u32 m0, s74, 0
    s_add_u32 s79, s77, 0
    buffer_load_dwordx4 v2, s[24:27], s79 offen   lds
    s_add_u32 s79, s77, 7168
    buffer_load_dwordx4 v3, s[24:27], s79 offen offset:1024  lds
    s_add_u32 s79, s77, 14336
    buffer_load_dwordx4 v2, s[24:27], s79 offen offset:2048  lds
    s_add_u32 s79, s77, 21504
    buffer_load_dwordx4 v3, s[24:27], s79 offen offset:3072  lds
    s_add_u32 m0, s75, 65536
    s_add_u32 s79, s78, 0
    buffer_load_dwordx4 v4, s[28:31], s79 offen   lds
    s_add_u32 s79, s78, 48128
    buffer_load_dwordx4 v4, s[28:31], s79 offen offset:1024  lds
    s_add_u32 m0, s75, 69632
    s_add_u32 s79, s78, 1024
    buffer_load_dwordx4 v4, s[28:31], s79 offen   lds
    s_add_u32 s79, s78, 49152
    buffer_load_dwordx4 v4, s[28:31], s79 offen offset:1024  lds
    s_add_u32 m0, s74, 4096
    s_add_u32 s79, s77, 32768
    buffer_load_dwordx4 v2, s[24:27], s79 offen   lds
    s_add_u32 s79, s77, 39936
    buffer_load_dwordx4 v3, s[24:27], s79 offen offset:1024  lds
    s_add_u32 s79, s77, 47104
    buffer_load_dwordx4 v2, s[24:27], s79 offen offset:2048  lds
    s_add_u32 s79, s77, 54272
    buffer_load_dwordx4 v3, s[24:27], s79 offen offset:3072  lds
    s_add_u32 m0, s75, 73728
    s_add_u32 s79, s78, 2048
    buffer_load_dwordx4 v4, s[28:31], s79 offen   lds
    s_add_u32 s79, s78, 50176
    buffer_load_dwordx4 v4, s[28:31], s79 offen offset:1024  lds
    s_add_u32 s78, s99, 1
    s_and_b32 s78, s78, 7
    s_lshl_b32 s77, s78, 7
    s_add_u32 s77, s77, s68
    s_mul_i32 s78, s78, 196608
    s_add_u32 s78, s78, s69
    s_add_u32 m0, s74, 16384
    s_add_u32 s79, s77, 0
    buffer_load_dwordx4 v2, s[24:27], s79 offen   lds
    s_add_u32 s79, s77, 7168
    buffer_load_dwordx4 v3, s[24:27], s79 offen offset:1024  lds
    s_add_u32 s79, s77, 14336
    buffer_load_dwordx4 v2, s[24:27], s79 offen offset:2048  lds
    s_add_u32 s79, s77, 21504
    buffer_load_dwordx4 v3, s[24:27], s79 offen offset:3072  lds
    s_add_u32 m0, s75, 81920
    s_add_u32 s79, s78, 0
    buffer_load_dwordx4 v4, s[28:31], s79 offen   lds
    s_add_u32 s79, s78, 48128
    buffer_load_dwordx4 v4, s[28:31], s79 offen offset:1024  lds
    s_add_u32 m0, s75, 86016
    s_add_u32 s79, s78, 1024
    buffer_load_dwordx4 v4, s[28:31], s79 offen   lds
    s_add_u32 s79, s78, 49152
    buffer_load_dwordx4 v4, s[28:31], s79 offen offset:1024  lds
    s_add_u32 m0, s74, 20480
    s_add_u32 s79, s77, 32768
    buffer_load_dwordx4 v2, s[24:27], s79 offen   lds
    s_add_u32 s79, s77, 39936
    buffer_load_dwordx4 v3, s[24:27], s79 offen offset:1024  lds
    s_add_u32 s79, s77, 47104
    buffer_load_dwordx4 v2, s[24:27], s79 offen offset:2048  lds
    s_add_u32 s79, s77, 54272
    buffer_load_dwordx4 v3, s[24:27], s79 offen offset:3072  lds
    s_add_u32 m0, s75, 90112
    s_add_u32 s79, s78, 2048
    buffer_load_dwordx4 v4, s[28:31], s79 offen   lds
    s_add_u32 s79, s78, 50176
    buffer_load_dwordx4 v4, s[28:31], s79 offen offset:1024  lds
    s_mov_b32 s32, s12
    s_and_b32 s33, s13, 0xffff
    s_mov_b32 s34, 1835008
    s_mov_b32 s35, 0x20000
    s_mov_b32 s52, s18
    s_and_b32 s53, s19, 0xffff
    s_mov_b32 s54, 256
    s_mov_b32 s55, 0x20000
    s_mov_b32 s48, s20
    s_and_b32 s49, s21, 0xffff
    s_mov_b32 s50, 17235968
    s_mov_b32 s51, 0x20000
    s_and_b32 s64, s58, 3
    s_lshl_b32 s64, s64, 2
    s_mul_i32 s65, s59, 448
    s_lshr_b32 s71, 0x3140, s64
    s_and_b32 s71, s71, 15
    s_lshl_b32 s71, s71, 6
    s_add_u32 s71, s71, s65
    s_lshr_b32 s72, 0x6073, s64
    s_and_b32 s72, s72, 15
    s_lshl_b32 s72, s72, 6
    s_add_u32 s72, s72, s65
    s_sub_u32 s72, s72, 64
    s_and_b32 s66, s62, 1
    s_lshl_b32 s74, s66, 13
    s_and_b32 s64, s2, 7
    s_lshr_b32 s65, s2, 3
    s_lshl_b32 s60, s64, 2
    s_and_b32 s66, s65, 3
    s_add_u32 s60, s60, s66
    s_lshr_b32 s61, s65, 2
    v_bfe_u32 v18, v0, 4, 1
    v_lshlrev_b32 v18, 2, v18
    v_and_b32 v5, 7, v0
    v_xor_b32 v5, v5, v18
    v_lshlrev_b32 v5, 4, v5
    v_lshrrev_b32 v18, 3, v0
    v_mul_u32_u24 v18, 3584, v18
    v_add_u32 v5, v5, v18
    s_waitcnt vmcnt(14)
    s_barrier
    s_add_u32 s78, s99, 2
    s_and_b32 s78, s78, 7
    s_lshl_b32 s77, s78, 7
    s_add_u32 s77, s77, s68
    s_mul_i32 s78, s78, 196608
    s_add_u32 s78, s78, s69
    s_add_u32 m0, s74, 32768
    s_add_u32 s79, s77, 0
    buffer_load_dwordx4 v2, s[24:27], s79 offen   lds
    s_add_u32 s79, s77, 7168
    buffer_load_dwordx4 v3, s[24:27], s79 offen offset:1024  lds
    s_add_u32 s79, s77, 14336
    buffer_load_dwordx4 v2, s[24:27], s79 offen offset:2048  lds
    s_add_u32 s79, s77, 21504
    buffer_load_dwordx4 v3, s[24:27], s79 offen offset:3072  lds
    s_add_u32 m0, s75, 98304
    s_add_u32 s79, s78, 0
    buffer_load_dwordx4 v4, s[28:31], s79 offen   lds
    s_add_u32 s79, s78, 48128
    buffer_load_dwordx4 v4, s[28:31], s79 offen offset:1024  lds
    s_add_u32 m0, s75, 102400
    s_add_u32 s79, s78, 1024
    buffer_load_dwordx4 v4, s[28:31], s79 offen   lds
    s_add_u32 s79, s78, 49152
    buffer_load_dwordx4 v4, s[28:31], s79 offen offset:1024  lds
    s_add_u32 m0, s74, 36864
    s_add_u32 s79, s77, 32768
    buffer_load_dwordx4 v2, s[24:27], s79 offen   lds
    s_add_u32 s79, s77, 39936
    buffer_load_dwordx4 v3, s[24:27], s79 offen offset:1024  lds
    s_add_u32 s79, s77, 47104
    buffer_load_dwordx4 v2, s[24:27], s79 offen offset:2048  lds
    s_add_u32 s79, s77, 54272
    buffer_load_dwordx4 v3, s[24:27], s79 offen offset:3072  lds
    s_add_u32 m0, s75, 106496
    s_add_u32 s79, s78, 2048
    buffer_load_dwordx4 v4, s[28:31], s79 offen   lds
    s_add_u32 s79, s78, 50176
    buffer_load_dwordx4 v4, s[28:31], s79 offen offset:1024  lds
    s_add_u32 s78, s99, 3
    s_and_b32 s78, s78, 7
    s_lshl_b32 s77, s78, 7
    s_add_u32 s77, s77, s68
    s_mul_i32 s78, s78, 196608
    s_add_u32 s78, s78, s69
    s_add_u32 m0, s74, 49152
    s_add_u32 s79, s77, 0
    buffer_load_dwordx4 v2, s[24:27], s79 offen   lds
    s_add_u32 s79, s77, 7168
    buffer_load_dwordx4 v3, s[24:27], s79 offen offset:1024  lds
    s_add_u32 s79, s77, 14336
    buffer_load_dwordx4 v2, s[24:27], s79 offen offset:2048  lds
    s_add_u32 s79, s77, 21504
    buffer_load_dwordx4 v3, s[24:27], s79 offen offset:3072  lds
    s_add_u32 m0, s75, 114688
    s_add_u32 s79, s78, 0
    buffer_load_dwordx4 v4, s[28:31], s79 offen   lds
    s_add_u32 s79, s78, 48128
    buffer_load_dwordx4 v4, s[28:31], s79 offen offset:1024  lds
    s_add_u32 m0, s75, 118784
    s_add_u32 s79, s78, 1024
    buffer_load_dwordx4 v4, s[28:31], s79 offen   lds
    s_add_u32 s79, s78, 49152
    buffer_load_dwordx4 v4, s[28:31], s79 offen offset:1024  lds
    s_add_u32 m0, s74, 53248
    s_add_u32 s79, s77, 32768
    buffer_load_dwordx4 v2, s[24:27], s79 offen   lds
    s_add_u32 s79, s77, 39936
    buffer_load_dwordx4 v3, s[24:27], s79 offen offset:1024  lds
    s_add_u32 s79, s77, 47104
    buffer_load_dwordx4 v2, s[24:27], s79 offen offset:2048  lds
    s_add_u32 s79, s77, 54272
    buffer_load_dwordx4 v3, s[24:27], s79 offen offset:3072  lds
    s_add_u32 m0, s75, 122880
    s_add_u32 s79, s78, 2048
    buffer_load_dwordx4 v4, s[28:31], s79 offen   lds
    s_add_u32 s79, s78, 50176
    buffer_load_dwordx4 v4, s[28:31], s79 offen offset:1024  lds
    s_waitcnt vmcnt(28)
    s_barrier
    s_add_u32 s78, s99, 4
    s_and_b32 s78, s78, 7
    s_lshl_b32 s77, s78, 7
    s_add_u32 s77, s77, s68
    s_mul_i32 s78, s78, 196608
    s_add_u32 s78, s78, s69
    s_add_u32 m0, s74, 0
    s_add_u32 s79, s77, 0
    buffer_load_dwordx4 v2, s[24:27], s79 offen   lds
    s_add_u32 s79, s77, 7168
    buffer_load_dwordx4 v3, s[24:27], s79 offen offset:1024  lds
    s_add_u32 s79, s77, 14336
    buffer_load_dwordx4 v2, s[24:27], s79 offen offset:2048  lds
    s_add_u32 s79, s77, 21504
    buffer_load_dwordx4 v3, s[24:27], s79 offen offset:3072  lds
    s_add_u32 m0, s75, 65536
    s_add_u32 s79, s78, 0
    buffer_load_dwordx4 v4, s[28:31], s79 offen   lds
    s_add_u32 s79, s78, 48128
    buffer_load_dwordx4 v4, s[28:31], s79 offen offset:1024  lds
    s_add_u32 m0, s75, 69632
    s_add_u32 s79, s78, 1024
    buffer_load_dwordx4 v4, s[28:31], s79 offen   lds
    s_add_u32 s79, s78, 49152
    buffer_load_dwordx4 v4, s[28:31], s79 offen offset:1024  lds
    s_add_u32 m0, s74, 4096
    s_add_u32 s79, s77, 32768
    buffer_load_dwordx4 v2, s[24:27], s79 offen   lds
    s_add_u32 s79, s77, 39936
    buffer_load_dwordx4 v3, s[24:27], s79 offen offset:1024  lds
    s_add_u32 s79, s77, 47104
    buffer_load_dwordx4 v2, s[24:27], s79 offen offset:2048  lds
    s_add_u32 s79, s77, 54272
    buffer_load_dwordx4 v3, s[24:27], s79 offen offset:3072  lds
    s_add_u32 m0, s75, 73728
    s_add_u32 s79, s78, 2048
    buffer_load_dwordx4 v4, s[28:31], s79 offen   lds
    s_add_u32 s79, s78, 50176
    buffer_load_dwordx4 v4, s[28:31], s79 offen offset:1024  lds
    s_waitcnt vmcnt(28)
    s_barrier
    s_add_u32 s78, s99, 5
    s_and_b32 s78, s78, 7
    s_lshl_b32 s77, s78, 7
    s_add_u32 s77, s77, s68
    s_mul_i32 s78, s78, 196608
    s_add_u32 s78, s78, s69
    s_add_u32 m0, s74, 16384
    s_add_u32 s79, s77, 0
    buffer_load_dwordx4 v2, s[24:27], s79 offen   lds
    s_add_u32 s79, s77, 7168
    buffer_load_dwordx4 v3, s[24:27], s79 offen offset:1024  lds
    s_add_u32 s79, s77, 14336
    buffer_load_dwordx4 v2, s[24:27], s79 offen offset:2048  lds
    s_add_u32 s79, s77, 21504
    buffer_load_dwordx4 v3, s[24:27], s79 offen offset:3072  lds
    s_add_u32 m0, s75, 81920
    s_add_u32 s79, s78, 0
    buffer_load_dwordx4 v4, s[28:31], s79 offen   lds
    s_add_u32 s79, s78, 48128
    buffer_load_dwordx4 v4, s[28:31], s79 offen offset:1024  lds
    s_add_u32 m0, s75, 86016
    s_add_u32 s79, s78, 1024
    buffer_load_dwordx4 v4, s[28:31], s79 offen   lds
    s_add_u32 s79, s78, 49152
    buffer_load_dwordx4 v4, s[28:31], s79 offen offset:1024  lds
    s_add_u32 m0, s74, 20480
    s_add_u32 s79, s77, 32768
    buffer_load_dwordx4 v2, s[24:27], s79 offen   lds
    s_add_u32 s79, s77, 39936
    buffer_load_dwordx4 v3, s[24:27], s79 offen offset:1024  lds
    s_add_u32 s79, s77, 47104
    buffer_load_dwordx4 v2, s[24:27], s79 offen offset:2048  lds
    s_add_u32 s79, s77, 54272
    buffer_load_dwordx4 v3, s[24:27], s79 offen offset:3072  lds
    s_add_u32 m0, s75, 90112
    s_add_u32 s79, s78, 2048
    buffer_load_dwordx4 v4, s[28:31], s79 offen   lds
    s_add_u32 s79, s78, 50176
    buffer_load_dwordx4 v4, s[28:31], s79 offen offset:1024  lds
    s_waitcnt vmcnt(28)
    s_barrier
    s_add_u32 s78, s99, 6
    s_and_b32 s78, s78, 7
    s_lshl_b32 s77, s78, 7
    s_add_u32 s77, s77, s68
    s_mul_i32 s78, s78, 196608
    s_add_u32 s78, s78, s69
    s_add_u32 m0, s74, 32768
    s_add_u32 s79, s77, 0
    buffer_load_dwordx4 v2, s[24:27], s79 offen   lds
    s_add_u32 s79, s77, 7168
    buffer_load_dwordx4 v3, s[24:27], s79 offen offset:1024  lds
    s_add_u32 s79, s77, 14336
    buffer_load_dwordx4 v2, s[24:27], s79 offen offset:2048  lds
    s_add_u32 s79, s77, 21504
    buffer_load_dwordx4 v3, s[24:27], s79 offen offset:3072  lds
    s_add_u32 m0, s75, 98304
    s_add_u32 s79, s78, 0
    buffer_load_dwordx4 v4, s[28:31], s79 offen   lds
    s_add_u32 s79, s78, 48128
    buffer_load_dwordx4 v4, s[28:31], s79 offen offset:1024  lds
    s_add_u32 m0, s75, 102400
    s_add_u32 s79, s78, 1024
    buffer_load_dwordx4 v4, s[28:31], s79 offen   lds
    s_add_u32 s79, s78, 49152
    buffer_load_dwordx4 v4, s[28:31], s79 offen offset:1024  lds
    s_add_u32 m0, s74, 36864
    s_add_u32 s79, s77, 32768
    buffer_load_dwordx4 v2, s[24:27], s79 offen   lds
    s_add_u32 s79, s77, 39936
    buffer_load_dwordx4 v3, s[24:27], s79 offen offset:1024  lds
    s_add_u32 s79, s77, 47104
    buffer_load_dwordx4 v2, s[24:27], s79 offen offset:2048  lds
    s_add_u32 s79, s77, 54272
    buffer_load_dwordx4 v3, s[24:27], s79 offen offset:3072  lds
    s_add_u32 m0, s75, 106496
    s_add_u32 s79, s78, 2048
    buffer_load_dwordx4 v4, s[28:31], s79 offen   lds
    s_add_u32 s79, s78, 50176
    buffer_load_dwordx4 v4, s[28:31], s79 offen offset:1024  lds
    s_waitcnt vmcnt(28)
    s_barrier
    s_add_u32 s78, s99, 7
    s_and_b32 s78, s78, 7
    s_lshl_b32 s77, s78, 7
    s_add_u32 s77, s77, s68
    s_mul_i32 s78, s78, 196608
    s_add_u32 s78, s78, s69
    s_add_u32 m0, s74, 49152
    s_add_u32 s79, s77, 0
    buffer_load_dwordx4 v2, s[24:27], s79 offen   lds
    s_add_u32 s79, s77, 7168
    buffer_load_dwordx4 v3, s[24:27], s79 offen offset:1024  lds
    s_add_u32 s79, s77, 14336
    buffer_load_dwordx4 v2, s[24:27], s79 offen offset:2048  lds
    s_add_u32 s79, s77, 21504
    buffer_load_dwordx4 v3, s[24:27], s79 offen offset:3072  lds
    s_add_u32 m0, s75, 114688
    s_add_u32 s79, s78, 0
    buffer_load_dwordx4 v4, s[28:31], s79 offen   lds
    s_add_u32 s79, s78, 48128
    buffer_load_dwordx4 v4, s[28:31], s79 offen offset:1024  lds
    s_add_u32 m0, s75, 118784
    s_add_u32 s79, s78, 1024
    buffer_load_dwordx4 v4, s[28:31], s79 offen   lds
    s_add_u32 s79, s78, 49152
    buffer_load_dwordx4 v4, s[28:31], s79 offen offset:1024  lds
    s_add_u32 m0, s74, 53248
    s_add_u32 s79, s77, 32768
    buffer_load_dwordx4 v2, s[24:27], s79 offen   lds
    s_add_u32 s79, s77, 39936
    buffer_load_dwordx4 v3, s[24:27], s79 offen offset:1024  lds
    s_add_u32 s79, s77, 47104
    buffer_load_dwordx4 v2, s[24:27], s79 offen offset:2048  lds
    s_add_u32 s79, s77, 54272
    buffer_load_dwordx4 v3, s[24:27], s79 offen offset:3072  lds
    s_add_u32 m0, s75, 122880
    s_add_u32 s79, s78, 2048
    buffer_load_dwordx4 v4, s[28:31], s79 offen   lds
    s_add_u32 s79, s78, 50176
    buffer_load_dwordx4 v4, s[28:31], s79 offen offset:1024  lds
    s_waitcnt vmcnt(28)
    s_barrier
    s_and_b32 s78, s62, 1
    s_add_u32 s78, s78, s99
    s_add_u32 s78, s78, 0
    s_and_b32 s78, s78, 7
    s_mul_i32 s78, s78, 229376
    s_add_u32 s78, s78, s71
    s_add_u32 m0, s74, 0
    s_add_u32 s79, s78, 0
    buffer_load_dwordx4 v5, s[32:35], s79 offen   lds
    s_add_u32 s79, s78, 27648
    buffer_load_dwordx4 v5, s[32:35], s79 offen offset:1024  lds
    s_add_u32 s79, s78, 55296
    buffer_load_dwordx4 v5, s[32:35], s79 offen offset:2048  lds
    s_add_u32 s79, s78, 82944
    buffer_load_dwordx4 v5, s[32:35], s79 offen offset:3072  lds
    s_add_u32 m0, s74, 4096
    s_add_u32 s79, s78, 114688
    buffer_load_dwordx4 v5, s[32:35], s79 offen   lds
    s_add_u32 s79, s78, 142336
    buffer_load_dwordx4 v5, s[32:35], s79 offen offset:1024  lds
    s_add_u32 s79, s78, 169984
    buffer_load_dwordx4 v5, s[32:35], s79 offen offset:2048  lds
    s_add_u32 s79, s78, 197632
    buffer_load_dwordx4 v5, s[32:35], s79 offen offset:3072  lds
    s_and_b32 s78, s62, 1
    s_add_u32 s78, s78, s99
    s_add_u32 s78, s78, 2
    s_and_b32 s78, s78, 7
    s_mul_i32 s78, s78, 229376
    s_add_u32 s78, s78, s71
    s_add_u32 m0, s74, 65536
    s_add_u32 s79, s78, 0
    buffer_load_dwordx4 v5, s[32:35], s79 offen   lds
    s_add_u32 s79, s78, 27648
    buffer_load_dwordx4 v5, s[32:35], s79 offen offset:1024  lds
    s_add_u32 s79, s78, 55296
    buffer_load_dwordx4 v5, s[32:35], s79 offen offset:2048  lds
    s_add_u32 s79, s78, 82944
    buffer_load_dwordx4 v5, s[32:35], s79 offen offset:3072  lds
    s_add_u32 m0, s74, 69632
    s_add_u32 s79, s78, 114688
    buffer_load_dwordx4 v5, s[32:35], s79 offen   lds
    s_add_u32 s79, s78, 142336
    buffer_load_dwordx4 v5, s[32:35], s79 offen offset:1024  lds
    s_add_u32 s79, s78, 169984
    buffer_load_dwordx4 v5, s[32:35], s79 offen offset:2048  lds
    s_add_u32 s79, s78, 197632
    buffer_load_dwordx4 v5, s[32:35], s79 offen offset:3072  lds
    s_waitcnt vmcnt(30)
    s_barrier
    s_and_b32 s78, s62, 1
    s_add_u32 s78, s78, s99
    s_add_u32 s78, s78, 4
    s_and_b32 s78, s78, 7
    s_mul_i32 s78, s78, 229376
    s_add_u32 s78, s78, s71
    s_add_u32 m0, s74, 16384
    s_add_u32 s79, s78, 0
    buffer_load_dwordx4 v5, s[32:35], s79 offen   lds
    s_add_u32 s79, s78, 27648
    buffer_load_dwordx4 v5, s[32:35], s79 offen offset:1024  lds
    s_add_u32 s79, s78, 55296
    buffer_load_dwordx4 v5, s[32:35], s79 offen offset:2048  lds
    s_add_u32 s79, s78, 82944
    buffer_load_dwordx4 v5, s[32:35], s79 offen offset:3072  lds
    s_add_u32 m0, s74, 20480
    s_add_u32 s79, s78, 114688
    buffer_load_dwordx4 v5, s[32:35], s79 offen   lds
    s_add_u32 s79, s78, 142336
    buffer_load_dwordx4 v5, s[32:35], s79 offen offset:1024  lds
    s_add_u32 s79, s78, 169984
    buffer_load_dwordx4 v5, s[32:35], s79 offen offset:2048  lds
    s_add_u32 s79, s78, 197632
    buffer_load_dwordx4 v5, s[32:35], s79 offen offset:3072  lds
    s_and_b32 s78, s62, 1
    s_add_u32 s78, s78, s99
    s_add_u32 s78, s78, 6
    s_and_b32 s78, s78, 7
    s_mul_i32 s78, s78, 229376
    s_add_u32 s78, s78, s71
    s_add_u32 m0, s74, 81920
    s_add_u32 s79, s78, 0
    buffer_load_dwordx4 v5, s[32:35], s79 offen   lds
    s_add_u32 s79, s78, 27648
    buffer_load_dwordx4 v5, s[32:35], s79 offen offset:1024  lds
    s_add_u32 s79, s78, 55296
    buffer_load_dwordx4 v5, s[32:35], s79 offen offset:2048  lds
    s_add_u32 s79, s78, 82944
    buffer_load_dwordx4 v5, s[32:35], s79 offen offset:3072  lds
    s_add_u32 m0, s74, 86016
    s_add_u32 s79, s78, 114688
    buffer_load_dwordx4 v5, s[32:35], s79 offen   lds
    s_add_u32 s79, s78, 142336
    buffer_load_dwordx4 v5, s[32:35], s79 offen offset:1024  lds
    s_add_u32 s79, s78, 169984
    buffer_load_dwordx4 v5, s[32:35], s79 offen offset:2048  lds
    s_add_u32 s79, s78, 197632
    buffer_load_dwordx4 v5, s[32:35], s79 offen offset:3072  lds
    s_waitcnt vmcnt(32)
    s_barrier
    buffer_load_dwordx2 v[8:9], v7, s[52:55], 0 offen sc1
    v_lshrrev_b32 v18, 3, v0
    v_lshlrev_b32 v18, 10, v18
    v_and_b32 v19, 7, v0
    v_lshl_add_u32 v18, v19, 4, v18
    s_lshl_b32 s65, s60, 16
    s_lshl_b32 s66, s62, 14
    s_add_u32 s65, s65, s66
    s_lshl_b32 s66, s61, 7
    s_add_u32 s65, s65, s66
    buffer_load_dwordx4 v[248:251], v18, s[24:27], s65 offen
    s_add_u32 s65, s65, 8192
    buffer_load_dwordx4 v[252:255], v18, s[24:27], s65 offen
    s_waitcnt vmcnt(19)
    s_barrier
    v_and_b32 v18, 31, v0
    v_lshrrev_b32 v19, 5, v0
    v_lshlrev_b32 v19, 2, v19
    v_sub_u32 v18, v18, v19
    v_subrev_u32 v72, 0, v18
    v_ashrrev_i32 v88, 31, v72
    v_subrev_u32 v73, 1, v18
    v_ashrrev_i32 v89, 31, v73
    v_subrev_u32 v74, 2, v18
    v_ashrrev_i32 v90, 31, v74
    v_subrev_u32 v75, 3, v18
    v_ashrrev_i32 v91, 31, v75
    v_subrev_u32 v76, 8, v18
    v_ashrrev_i32 v92, 31, v76
    v_subrev_u32 v77, 9, v18
    v_ashrrev_i32 v93, 31, v77
    v_subrev_u32 v78, 10, v18
    v_ashrrev_i32 v94, 31, v78
    v_subrev_u32 v79, 11, v18
    v_ashrrev_i32 v95, 31, v79
    v_subrev_u32 v80, 16, v18
    v_ashrrev_i32 v96, 31, v80
    v_subrev_u32 v81, 17, v18
    v_ashrrev_i32 v97, 31, v81
    v_subrev_u32 v82, 18, v18
    v_ashrrev_i32 v98, 31, v82
    v_subrev_u32 v83, 19, v18
    v_ashrrev_i32 v99, 31, v83
    v_subrev_u32 v84, 24, v18
    v_ashrrev_i32 v100, 31, v84
    v_subrev_u32 v85, 25, v18
    v_ashrrev_i32 v101, 31, v85
    v_subrev_u32 v86, 26, v18
    v_ashrrev_i32 v102, 31, v86
    v_subrev_u32 v87, 27, v18
    v_ashrrev_i32 v103, 31, v87
    v_and_b32 v16, 0xffff, v88
    v_and_b32 v17, 0xffff0000, v89
    v_or_b32 v16, v16, v17
    v_not_b32 v104, v16
    v_and_b32 v16, 0xffff, v90
    v_and_b32 v17, 0xffff0000, v91
    v_or_b32 v16, v16, v17
    v_not_b32 v105, v16
    v_and_b32 v16, 0xffff, v92
    v_and_b32 v17, 0xffff0000, v93
    v_or_b32 v16, v16, v17
    v_not_b32 v106, v16
    v_and_b32 v16, 0xffff, v94
    v_and_b32 v17, 0xffff0000, v95
    v_or_b32 v16, v16, v17
    v_not_b32 v107, v16
    v_and_b32 v16, 0xffff, v96
    v_and_b32 v17, 0xffff0000, v97
    v_or_b32 v16, v16, v17
    v_not_b32 v108, v16
    v_and_b32 v16, 0xffff, v98
    v_and_b32 v17, 0xffff0000, v99
    v_or_b32 v16, v16, v17
    v_not_b32 v109, v16
    v_and_b32 v16, 0xffff, v100
    v_and_b32 v17, 0xffff0000, v101
    v_or_b32 v16, v16, v17
    v_not_b32 v110, v16
    v_and_b32 v16, 0xffff, v102
    v_and_b32 v17, 0xffff0000, v103
    v_or_b32 v16, v16, v17
    v_not_b32 v111, v16
    v_and_b32 v72, 0xff800000, v88
    v_xor_b32 v88, 0xff800000, v72
    v_and_b32 v73, 0xff800000, v89
    v_xor_b32 v89, 0xff800000, v73
    v_and_b32 v74, 0xff800000, v90
    v_xor_b32 v90, 0xff800000, v74
    v_and_b32 v75, 0xff800000, v91
    v_xor_b32 v91, 0xff800000, v75
    v_and_b32 v76, 0xff800000, v92
    v_xor_b32 v92, 0xff800000, v76
    v_and_b32 v77, 0xff800000, v93
    v_xor_b32 v93, 0xff800000, v77
    v_and_b32 v78, 0xff800000, v94
    v_xor_b32 v94, 0xff800000, v78
    v_and_b32 v79, 0xff800000, v95
    v_xor_b32 v95, 0xff800000, v79
    v_and_b32 v80, 0xff800000, v96
    v_xor_b32 v96, 0xff800000, v80
    v_and_b32 v81, 0xff800000, v97
    v_xor_b32 v97, 0xff800000, v81
    v_and_b32 v82, 0xff800000, v98
    v_xor_b32 v98, 0xff800000, v82
    v_and_b32 v83, 0xff800000, v99
    v_xor_b32 v99, 0xff800000, v83
    v_and_b32 v84, 0xff800000, v100
    v_xor_b32 v100, 0xff800000, v84
    v_and_b32 v85, 0xff800000, v101
    v_xor_b32 v101, 0xff800000, v85
    v_and_b32 v86, 0xff800000, v102
    v_xor_b32 v102, 0xff800000, v86
    v_and_b32 v87, 0xff800000, v103
    v_xor_b32 v103, 0xff800000, v87
    s_waitcnt vmcnt(2)
    s_mov_b32 s82, 0
L_non_p_160:
    v_readfirstlane_b32 s80, v8
    v_readfirstlane_b32 s81, v9
    s_cmp_lg_u32 s80, 0
    s_cbranch_scc1 L_non_d_161
    s_add_u32 s82, s82, 1
    s_cmp_gt_u32 s82, 60000
    s_cbranch_scc1 L_non_d_161
    buffer_load_dwordx2 v[8:9], v7, s[52:55], 0 offen sc1
    s_waitcnt vmcnt(0)
    s_branch L_non_p_160
L_non_d_161:
    s_barrier
    v_lshlrev_b32 v10, 4, v0
    v_mov_b32 v14, 158720
    v_mov_b32 v15, 1
    s_and_b32 s64, s62, 1
    s_lshl_b32 s92, s58, 1
    s_add_u32 s92, s92, s64
    s_lshr_b32 s65, s62, 1
    s_lshl_b32 s93, s57, 2
    s_lshl_b32 s66, s65, 1
    s_add_u32 s93, s93, s66
    s_mul_i32 s95, s64, 12288
    s_add_u32 s95, s95, 131072
    s_lshl_b32 s22, s64, 16
    s_add_u32 s22, s22, 49152
    s_mov_b32 s94, 11526144
    s_lshl_b32 s66, s92, 16
    s_add_u32 s94, s94, s66
    s_lshl_b32 s67, s57, 12
    s_add_u32 s94, s94, s67
    s_lshl_b32 s65, s57, 2
    s_sub_u32 s65, s65, 8
    v_add_u32 v11, s65, v0
    v_lshlrev_b32 v11, 5, v11
    v_add_u32 v11, s58, v11
    v_lshlrev_b32 v11, 7, v11
    v_add_u32 v11, 15728640, v11
    s_lshl_b32 s65, s57, 2
    s_sub_i32 s65, 8, s65
    s_max_i32 s65, s65, 0
    s_lshl_b32 s10, 0xff, s65
    s_and_b32 s10, s10, 0xff
    s_mov_b32 s11, 0
    s_and_b32 s64, s62, 1
    s_mul_i32 s66, s64, 12288
    s_lshr_b32 s65, s62, 1
    s_lshl_b32 s65, s65, 11
    s_add_u32 s66, s66, s65
    s_add_u32 s66, s66, 131072
    v_add_u32 v12, s66, v10
    s_lshl_b32 s3, s64, 16
    s_add_u32 s3, s3, s65
    s_add_u32 s3, s3, 49152
    s_mul_i32 s96, s93, 147456
    s_lshl_b32 s64, s92, 10
    s_add_u32 s96, s96, s64
    s_add_u32 s96, s96, 114688
    s_lshl_b32 s97, s93, 5
    s_add_u32 s97, s97, s92
    s_lshl_b32 s97, s97, 7
    s_add_u32 s97, s97, 16515072
    s_add_u32 s23, s3, 12288
    v_add_u32 v13, s23, v10
    v_lshrrev_b32 v18, 5, v0
    v_lshlrev_b32 v22, 7, v18
    v_bfe_u32 v19, v0, 2, 2
    v_lshl_add_u32 v22, v19, 5, v22
    v_bfe_u32 v19, v0, 0, 1
    v_lshl_add_u32 v22, v19, 4, v22
    v_bfe_u32 v19, v0, 1, 1
    v_lshl_add_u32 v22, v19, 3, v22
    v_add_u32 v22, s3, v22
    v_xor_b32 v18, 1, v18
    v_lshlrev_b32 v18, 7, v18
    v_and_b32 v19, 15, v0
    v_lshl_add_u32 v18, v19, 3, v18
    v_add_u32 v18, 157696, v18
    v_bfe_u32 v19, v0, 4, 1
    v_cmp_eq_u32 vcc, 0, v19
    s_add_u32 s17, s93, 1
    s_min_u32 s17, s17, 9
    v_cndmask_b32 v22, v18, v22, vcc
    v_mov_b32 v18, 1024
    v_cndmask_b32 v21, 0, v18, vcc
    s_add_u32 s83, s93, 2
    s_min_u32 s83, s83, 9
    s_mov_b32 s36, s14
    s_and_b32 s37, s15, 0xffff
    s_mov_b32 s38, 1835008
    s_mov_b32 s39, 0x20000
    v_bfe_u32 v18, v0, 4, 1
    v_lshlrev_b32 v18, 2, v18
    v_and_b32 v6, 7, v0
    v_xor_b32 v6, v6, v18
    v_lshlrev_b32 v6, 4, v6
    v_lshrrev_b32 v18, 3, v0
    v_mul_u32_u24 v18, 1024, v18
    v_add_u32 v6, v6, v18
    s_cmp_eq_u32 s57, 0
    s_cbranch_scc1 L_nohalo_162
    s_lshl_b32 s64, s57, 14
    s_lshl_b32 s65, s58, 7
    s_add_u32 s64, s64, s65
    s_add_u32 s64, s64, 15695872
    s_add_u32 s20, s20, s64
    s_addc_u32 s21, s21, 0
    s_mov_b32 s82, 0
L_qa_p_163:
    s_load_dword s24, s[20:21], 16384 glc
    s_load_dword s25, s[20:21], 20480 glc
    s_load_dword s26, s[20:21], 24576 glc
    s_load_dword s27, s[20:21], 28672 glc
    s_add_u32 s82, s82, 1
    s_waitcnt lgkmcnt(0)
    s_xor_b32 s24, s24, s80
    s_xor_b32 s25, s25, s80
    s_or_b32 s24, s24, s25
    s_xor_b32 s26, s26, s80
    s_or_b32 s24, s24, s26
    s_xor_b32 s27, s27, s80
    s_or_b32 s24, s24, s27
    s_cbranch_scc0 L_qa_d_164
    s_cmp_gt_u32 s82, 60000
    s_cbranch_scc1 L_qa_d_164
    s_sleep 8
    s_branch L_qa_p_163
L_qa_d_164:
    s_cmp_eq_u32 s57, 1
    s_cbranch_scc1 L_q4_165
    s_mov_b32 s82, 0
L_qb_p_166:
    s_load_dword s24, s[20:21], 0 glc
    s_load_dword s25, s[20:21], 4096 glc
    s_load_dword s26, s[20:21], 8192 glc
    s_load_dword s27, s[20:21], 12288 glc
    s_add_u32 s82, s82, 1
    s_waitcnt lgkmcnt(0)
    s_xor_b32 s24, s24, s80
    s_xor_b32 s25, s25, s80
    s_or_b32 s24, s24, s25
    s_xor_b32 s26, s26, s80
    s_or_b32 s24, s24, s26
    s_xor_b32 s27, s27, s80
    s_or_b32 s24, s24, s27
    s_cbranch_scc0 L_qb_d_167
    s_cmp_gt_u32 s82, 60000
    s_cbranch_scc1 L_qb_d_167
    s_sleep 8
    s_branch L_qb_p_166
L_qb_d_167:
L_q4_165:
    s_add_u32 m0, s95, 0
    s_add_u32 s79, s94, 0
    buffer_load_dwordx4 v10, s[48:51], s79 offen  sc1 lds
    s_add_u32 s79, s94, 0
    buffer_load_dwordx4 v10, s[48:51], s79 offen offset:1024 sc1 lds
    s_add_u32 s79, s94, 0
    buffer_load_dwordx4 v10, s[48:51], s79 offen offset:2048 sc1 lds
    s_add_u32 s79, s94, 0
    buffer_load_dwordx4 v10, s[48:51], s79 offen offset:3072 sc1 lds
    s_add_u32 m0, s95, 4096
    s_add_u32 s79, s94, 4096
    buffer_load_dwordx4 v10, s[48:51], s79 offen  sc1 lds
    s_add_u32 s79, s94, 4096
    buffer_load_dwordx4 v10, s[48:51], s79 offen offset:1024 sc1 lds
    s_add_u32 s79, s94, 4096
    buffer_load_dwordx4 v10, s[48:51], s79 offen offset:2048 sc1 lds
    s_add_u32 s79, s94, 4096
    buffer_load_dwordx4 v10, s[48:51], s79 offen offset:3072 sc1 lds
    s_add_u32 m0, s22, 0
    s_add_u32 s79, s94, 2097152
    buffer_load_dwordx4 v10, s[48:51], s79 offen  sc1 lds
    s_add_u32 s79, s94, 2097152
    buffer_load_dwordx4 v10, s[48:51], s79 offen offset:1024 sc1 lds
    s_add_u32 s79, s94, 2097152
    buffer_load_dwordx4 v10, s[48:51], s79 offen offset:2048 sc1 lds
    s_add_u32 s79, s94, 2097152
    buffer_load_dwordx4 v10, s[48:51], s79 offen offset:3072 sc1 lds
    s_add_u32 m0, s22, 4096
    s_add_u32 s79, s94, 2101248
    buffer_load_dwordx4 v10, s[48:51], s79 offen  sc1 lds
    s_add_u32 s79, s94, 2101248
    buffer_load_dwordx4 v10, s[48:51], s79 offen offset:1024 sc1 lds
    s_add_u32 s79, s94, 2101248
    buffer_load_dwordx4 v10, s[48:51], s79 offen offset:2048 sc1 lds
    s_add_u32 s79, s94, 2101248
    buffer_load_dwordx4 v10, s[48:51], s79 offen offset:3072 sc1 lds
    s_waitcnt vmcnt(8)
L_nohalo_162:
    s_mov_b64 exec, 1
    ds_add_u32 v14, v15 offset:0
    s_mov_b64 exec, -1
    s_branch L_rej_159
L_hB_158:
    s_and_b32 s22, s57, 1
    s_xor_b32 s22, s22, s58
    s_add_u32 s23, s58, 1
    s_lshr_b32 s23, s23, 1
    s_and_b32 s23, s23, 1
    s_and_b32 s64, s22, 3
    s_lshl_b32 s64, s64, 2
    s_mul_i32 s65, s59, 448
    s_lshr_b32 s71, 0x3140, s64
    s_and_b32 s71, s71, 15
    s_lshl_b32 s71, s71, 6
    s_add_u32 s71, s71, s65
    s_lshr_b32 s72, 0x6073, s64
    s_and_b32 s72, s72, 15
    s_lshl_b32 s72, s72, 6
    s_add_u32 s72, s72, s65
    s_sub_u32 s72, s72, 64
    s_and_b32 s75, s62, 1
    s_mov_b32 s64, s23
    s_lshl_b32 s65, s64, 9
    s_add_u32 s65, s65, 3072
    s_lshl_b32 s67, s22, 6
    s_add_u32 s66, s67, 2048
    s_cmp_eq_u32 s64, 0
    s_cselect_b32 s67, s67, s71
    s_cselect_b32 s66, s66, s72
    s_cmp_eq_u32 s75, 0
    s_cselect_b32 s66, s67, s66
    s_lshr_b32 s67, s57, 1
    s_lshl_b32 s67, s67, 6
    s_mul_i32 s67, s67, s65
    s_add_u32 s66, s66, s67
    v_lshrrev_b32 v190, 3, v0
    v_mul_u32_u24 v190, s65, v190
    v_and_b32 v18, 3, v0
    v_lshl_add_u32 v190, v18, 4, v190
    s_lshl_b32 s77, s75, 1
    s_or_b32 s77, s77, s64
    s_lshl_b32 s77, s77, 3
    s_lshr_b32 s77, 0x04000440, s77
    s_and_b32 s77, s77, 0xff
    s_lshl_b32 s77, s77, 4
    v_bfe_u32 v18, v0, 2, 1
    v_mul_u32_u24 v18, s77, v18
    v_add_u32 v190, v190, v18
    s_lshl_b32 s65, s65, 3
    s_lshl_b32 s78, s57, 4
    s_add_u32 s78, s78, s58
    s_lshl_b32 s78, s78, 1
    s_add_u32 s78, s78, s75
    s_lshl_b32 s67, s78, 12
    v_lshrrev_b32 v191, 4, v0
    v_lshlrev_b32 v191, 10, v191
    v_and_b32 v18, 15, v0
    v_lshl_add_u32 v191, v18, 4, v191
    s_cmp_eq_u32 s64, 0
    s_waitcnt lgkmcnt(0)
    s_cselect_b32 s44, s6, s12
    s_cselect_b32 s45, s7, s13
    s_cselect_b32 s46, 6, 7
    s_mov_b32 s47, 0x20000
    s_lshl_b32 s46, s46, 18
    s_and_b32 s45, s45, 0xffff
    s_mov_b32 s24, s4
    s_and_b32 s25, s5, 0xffff
    s_mov_b32 s26, 2097152
    s_mov_b32 s27, 0x20000
    s_mov_b32 s92, s67
    s_mov_b32 s93, s66
    s_mov_b32 s94, s65
    v_mov_b32 v120, v190
    v_mov_b32 v121, v191
    buffer_load_dwordx4 v[160:163], v121, s[24:27], s92 offen offset:0
    buffer_load_dwordx4 v[164:167], v121, s[24:27], s92 offen offset:256
    buffer_load_dwordx4 v[168:171], v121, s[24:27], s92 offen offset:512
    buffer_load_dwordx4 v[172:175], v121, s[24:27], s92 offen offset:768
    buffer_load_dwordx4 v[128:131], v120, s[44:47], s93 offen
    s_add_u32 s93, s93, s94
    buffer_load_dwordx4 v[132:135], v120, s[44:47], s93 offen
    s_add_u32 s93, s93, s94
    buffer_load_dwordx4 v[136:139], v120, s[44:47], s93 offen
    s_add_u32 s93, s93, s94
    buffer_load_dwordx4 v[140:143], v120, s[44:47], s93 offen
    s_add_u32 s93, s93, s94
    buffer_load_dwordx4 v[144:147], v120, s[44:47], s93 offen
    s_add_u32 s93, s93, s94
    buffer_load_dwordx4 v[148:151], v120, s[44:47], s93 offen
    s_add_u32 s93, s93, s94
    buffer_load_dwordx4 v[152:155], v120, s[44:47], s93 offen
    s_add_u32 s93, s93, s94
    buffer_load_dwordx4 v[156:159], v120, s[44:47], s93 offen
    s_add_u32 s93, s93, s94
    s_mov_b32 s52, s18
    s_and_b32 s53, s19, 0xffff
    s_mov_b32 s54, 256
    s_mov_b32 s55, 0x20000
    s_mov_b32 s48, s20
    s_and_b32 s49, s21, 0xffff
    s_mov_b32 s50, 17235968
    s_mov_b32 s51, 0x20000
    s_mov_b32 s32, s12
    s_and_b32 s33, s13, 0xffff
    s_mov_b32 s34, 1835008
    s_mov_b32 s35, 0x20000
    s_mov_b32 s36, s14
    s_and_b32 s37, s15, 0xffff
    s_mov_b32 s38, 1835008
    s_mov_b32 s39, 0x20000
    v_bfe_u32 v18, v0, 4, 1
    v_lshlrev_b32 v18, 2, v18
    v_and_b32 v5, 7, v0
    v_xor_b32 v5, v5, v18
    v_lshlrev_b32 v5, 4, v5
    v_lshrrev_b32 v18, 3, v0
    v_mul_u32_u24 v18, 3584, v18
    v_add_u32 v5, v5, v18
    v_bfe_u32 v18, v0, 4, 1
    v_lshlrev_b32 v18, 2, v18
    v_and_b32 v6, 7, v0
    v_xor_b32 v6, v6, v18
    v_lshlrev_b32 v6, 4, v6
    v_lshrrev_b32 v18, 3, v0
    v_mul_u32_u24 v18, 1024, v18
    v_add_u32 v6, v6, v18
    s_lshl_b32 s64, s23, 1
    s_add_u32 s64, s64, s75
    s_lshl2_add_u32 s64, s22, s64
    s_lshl_b32 s64, s64, 3
    s_lshr_b32 s65, s57, 1
    s_add_u32 s64, s64, s65
    s_lshl_b32 s64, s64, 9
    s_add_u32 s77, s64, 16842752
    s_lshl_b32 s78, s78, 6
    s_add_u32 s78, s78, 16777216
    s_lshl_b32 s66, s75, 1
    v_lshlrev_b32 v188, 4, v0
    s_lshl2_add_u32 s64, s58, s66
    s_lshl_b32 s64, s64, 12
    s_add_u32 s68, s64, 16842752
    s_add_u32 s69, s68, 4096
    v_and_b32 v18, 31, v0
    v_lshrrev_b32 v19, 5, v0
    v_lshl_add_u32 v189, v18, 1, v19
    v_lshlrev_b32 v189, 2, v189
    s_lshl_b32 s64, s66, 8
    s_add_u32 s65, s64, 156672
    v_add_u32 v189, s65, v189
    v_bfe_u32 v18, v0, 3, 1
    v_and_b32 v190, 7, v0
    v_lshl_add_u32 v190, v190, 3, v18
    v_bfe_u32 v18, v0, 4, 2
    v_lshl_add_u32 v190, v18, 1, v190
    v_lshlrev_b32 v190, 3, v190
    v_and_b32 v191, 48, v0
    s_and_b32 s64, s58, 3
    s_lshl_b32 s64, s64, 2
    s_mul_i32 s65, s59, 448
    s_lshr_b32 s71, 0x3140, s64
    s_and_b32 s71, s71, 15
    s_lshl_b32 s71, s71, 6
    s_add_u32 s71, s71, s65
    s_lshr_b32 s72, 0x6073, s64
    s_and_b32 s72, s72, 15
    s_lshl_b32 s72, s72, 6
    s_add_u32 s72, s72, s65
    s_sub_u32 s72, s72, 64
    s_and_b32 s66, s62, 1
    s_lshl_b32 s74, s66, 13
    s_and_b32 s64, s2, 7
    s_lshr_b32 s65, s2, 3
    s_lshl_b32 s60, s64, 2
    s_and_b32 s66, s65, 3
    s_add_u32 s60, s60, s66
    s_lshr_b32 s61, s65, 2
    s_and_b32 s64, s60, 0
    s_lshl_b32 s64, s64, 2
    s_add_u32 s64, s64, s61
    s_lshl_b32 s64, s64, 1
    s_lshl_b32 s65, s75, 2
    s_add_u32 s64, s64, s65
    s_add_u32 s73, s64, 0
    s_and_b32 s73, s73, 15
    s_lshr_b32 s65, s73, 2
    s_min_u32 s65, s65, 2
    s_lshl2_add_u32 s73, s65, s73
    s_add_u32 s76, s64, 2
    s_and_b32 s76, s76, 15
    s_lshr_b32 s65, s76, 2
    s_min_u32 s65, s65, 2
    s_lshl2_add_u32 s76, s65, s76
    s_lshl_b32 s64, s61, 7
    s_lshl_b32 s73, s73, 14
    s_add_u32 s73, s73, s64
    s_lshl_b32 s76, s76, 14
    s_add_u32 s76, s76, s64
    s_mov_b32 s66, 0x3f80
    s_mov_b32 s67, 0x3f800000
    s_mov_b32 s70, 0x3f803f80
    buffer_load_dwordx2 v[8:9], v7, s[52:55], 0 offen sc1
    s_barrier
    s_waitcnt vmcnt(9)
    v_dot2_f32_bf16 v176, v160, s70, 0
    v_dot2_f32_bf16 v178, v160, v160, 0
    v_dot2_f32_bf16 v177, v161, s70, 0
    v_dot2_f32_bf16 v179, v161, v161, 0
    v_dot2_f32_bf16 v176, v162, s70, v176
    v_dot2_f32_bf16 v178, v162, v162, v178
    v_dot2_f32_bf16 v177, v163, s70, v177
    v_dot2_f32_bf16 v179, v163, v163, v179
    v_dot2_f32_bf16 v176, v164, s70, v176
    v_dot2_f32_bf16 v178, v164, v164, v178
    v_dot2_f32_bf16 v177, v165, s70, v177
    v_dot2_f32_bf16 v179, v165, v165, v179
    v_dot2_f32_bf16 v176, v166, s70, v176
    v_dot2_f32_bf16 v178, v166, v166, v178
    v_dot2_f32_bf16 v177, v167, s70, v177
    v_dot2_f32_bf16 v179, v167, v167, v179
    v_dot2_f32_bf16 v176, v168, s70, v176
    v_dot2_f32_bf16 v178, v168, v168, v178
    v_dot2_f32_bf16 v177, v169, s70, v177
    v_dot2_f32_bf16 v179, v169, v169, v179
    v_dot2_f32_bf16 v176, v170, s70, v176
    v_dot2_f32_bf16 v178, v170, v170, v178
    v_dot2_f32_bf16 v177, v171, s70, v177
    v_dot2_f32_bf16 v179, v171, v171, v179
    v_dot2_f32_bf16 v176, v172, s70, v176
    v_dot2_f32_bf16 v178, v172, v172, v178
    v_dot2_f32_bf16 v177, v173, s70, v177
    v_dot2_f32_bf16 v179, v173, v173, v179
    v_dot2_f32_bf16 v176, v174, s70, v176
    v_dot2_f32_bf16 v178, v174, v174, v178
    v_dot2_f32_bf16 v177, v175, s70, v177
    v_dot2_f32_bf16 v179, v175, v175, v179
    s_nop 2
    v_add_f32 v176, v176, v177
    v_add_f32 v178, v178, v179
    s_nop 0
    v_add_f32_dpp v176, v176, v176 row_ror:8 row_mask:0xf bank_mask:0xf
    v_add_f32_dpp v178, v178, v178 row_ror:8 row_mask:0xf bank_mask:0xf
    s_nop 0
    v_add_f32_dpp v176, v176, v176 row_ror:4 row_mask:0xf bank_mask:0xf
    v_add_f32_dpp v178, v178, v178 row_ror:4 row_mask:0xf bank_mask:0xf
    s_nop 0
    v_add_f32_dpp v176, v176, v176 row_ror:2 row_mask:0xf bank_mask:0xf
    v_add_f32_dpp v178, v178, v178 row_ror:2 row_mask:0xf bank_mask:0xf
    s_nop 0
    v_add_f32_dpp v176, v176, v176 row_ror:1 row_mask:0xf bank_mask:0xf
    v_add_f32_dpp v178, v178, v178 row_ror:1 row_mask:0xf bank_mask:0xf
    v_mul_f32 v176, 0x3b000000, v176
    v_mul_f32 v178, 0x3b000000, v178
    v_fma_f32 v178, -v176, v176, v178
    v_max_f32 v178, 0, v178
    v_cvt_pk_bf16_f32 v184, -v176, -v176
    v_cvt_pk_bf16_f32 v178, v178, v178
    v_and_b32 v178, 0xffff0000, v178
    v_add_f32 v178, 0x3727c5ac, v178
    v_cvt_pk_bf16_f32 v178, v178, v178
    v_and_b32 v178, 0xffff0000, v178
    v_sqrt_f32 v178, v178
    s_nop 0
    v_cvt_pk_bf16_f32 v178, v178, v178
    v_and_b32 v178, 0xffff0000, v178
    v_rcp_f32 v185, v178
    s_waitcnt vmcnt(1)
    v_dot2_f32_bf16 v176, v128, s66, 0
    v_dot2_f32_bf16 v177, v128, s67, 0
    v_dot2_f32_bf16 v178, v129, s66, 0
    v_dot2_f32_bf16 v179, v129, s67, 0
    v_dot2_f32_bf16 v180, v130, s66, 0
    v_dot2_f32_bf16 v181, v130, s67, 0
    v_dot2_f32_bf16 v182, v131, s66, 0
    v_dot2_f32_bf16 v183, v131, s67, 0
    v_dot2_f32_bf16 v176, v132, s66, v176
    v_dot2_f32_bf16 v177, v132, s67, v177
    v_dot2_f32_bf16 v178, v133, s66, v178
    v_dot2_f32_bf16 v179, v133, s67, v179
    v_dot2_f32_bf16 v180, v134, s66, v180
    v_dot2_f32_bf16 v181, v134, s67, v181
    v_dot2_f32_bf16 v182, v135, s66, v182
    v_dot2_f32_bf16 v183, v135, s67, v183
    v_dot2_f32_bf16 v176, v136, s66, v176
    v_dot2_f32_bf16 v177, v136, s67, v177
    v_dot2_f32_bf16 v178, v137, s66, v178
    v_dot2_f32_bf16 v179, v137, s67, v179
    v_dot2_f32_bf16 v180, v138, s66, v180
    v_dot2_f32_bf16 v181, v138, s67, v181
    v_dot2_f32_bf16 v182, v139, s66, v182
    v_dot2_f32_bf16 v183, v139, s67, v183
    v_dot2_f32_bf16 v176, v140, s66, v176
    v_dot2_f32_bf16 v177, v140, s67, v177
    v_dot2_f32_bf16 v178, v141, s66, v178
    v_dot2_f32_bf16 v179, v141, s67, v179
    v_dot2_f32_bf16 v180, v142, s66, v180
    v_dot2_f32_bf16 v181, v142, s67, v181
    v_dot2_f32_bf16 v182, v143, s66, v182
    v_dot2_f32_bf16 v183, v143, s67, v183
    v_dot2_f32_bf16 v176, v144, s66, v176
    v_dot2_f32_bf16 v177, v144, s67, v177
    v_dot2_f32_bf16 v178, v145, s66, v178
    v_dot2_f32_bf16 v179, v145, s67, v179
    v_dot2_f32_bf16 v180, v146, s66, v180
    v_dot2_f32_bf16 v181, v146, s67, v181
    v_dot2_f32_bf16 v182, v147, s66, v182
    v_dot2_f32_bf16 v183, v147, s67, v183
    v_dot2_f32_bf16 v176, v148, s66, v176
    v_dot2_f32_bf16 v177, v148, s67, v177
    v_dot2_f32_bf16 v178, v149, s66, v178
    v_dot2_f32_bf16 v179, v149, s67, v179
    v_dot2_f32_bf16 v180, v150, s66, v180
    v_dot2_f32_bf16 v181, v150, s67, v181
    v_dot2_f32_bf16 v182, v151, s66, v182
    v_dot2_f32_bf16 v183, v151, s67, v183
    v_dot2_f32_bf16 v176, v152, s66, v176
    v_dot2_f32_bf16 v177, v152, s67, v177
    v_dot2_f32_bf16 v178, v153, s66, v178
    v_dot2_f32_bf16 v179, v153, s67, v179
    v_dot2_f32_bf16 v180, v154, s66, v180
    v_dot2_f32_bf16 v181, v154, s67, v181
    v_dot2_f32_bf16 v182, v155, s66, v182
    v_dot2_f32_bf16 v183, v155, s67, v183
    v_dot2_f32_bf16 v176, v156, s66, v176
    v_dot2_f32_bf16 v177, v156, s67, v177
    v_dot2_f32_bf16 v178, v157, s66, v178
    v_dot2_f32_bf16 v179, v157, s67, v179
    v_dot2_f32_bf16 v180, v158, s66, v180
    v_dot2_f32_bf16 v181, v158, s67, v181
    v_dot2_f32_bf16 v182, v159, s66, v182
    v_dot2_f32_bf16 v183, v159, s67, v183
    s_nop 2
    v_permlane32_swap_b32 v176, v180
    v_permlane32_swap_b32 v177, v181
    v_permlane32_swap_b32 v178, v182
    v_permlane32_swap_b32 v179, v183
    v_add_f32 v176, v176, v180
    v_add_f32 v177, v177, v181
    v_add_f32 v178, v178, v182
    v_add_f32 v179, v179, v183
    s_nop 0
    v_permlane16_swap_b32 v176, v178
    v_permlane16_swap_b32 v177, v179
    v_add_f32 v176, v176, v178
    v_add_f32 v177, v177, v179
    s_nop 0
    v_add_f32_dpp v178, v176, v176 row_ror:8 row_mask:0xf bank_mask:0xf
    v_add_f32_dpp v179, v177, v177 row_ror:8 row_mask:0xf bank_mask:0xf
    v_and_b32 v18, 8, v0
    v_cmp_ne_u32 vcc, 0, v18
    s_nop 1
    v_cndmask_b32 v176, v178, v179, vcc
    s_waitcnt vmcnt(0)
    s_mov_b32 s82, 0
L_non_p_168:
    v_readfirstlane_b32 s80, v8
    v_readfirstlane_b32 s81, v9
    s_cmp_lg_u32 s80, 0
    s_cbranch_scc1 L_non_d_169
    s_add_u32 s82, s82, 1
    s_cmp_gt_u32 s82, 60000
    s_cbranch_scc1 L_non_d_169
    buffer_load_dwordx2 v[8:9], v7, s[52:55], 0 offen sc1
    s_waitcnt vmcnt(0)
    s_branch L_non_p_168
L_non_d_169:
    v_mov_b32 v177, s80
    buffer_store_dwordx2 v[176:177], v190, s[48:51], s77 offen sc1
    v_mov_b32 v186, s80
    v_mov_b32 v187, s81
    s_mov_b32 exec_lo, 0x10001
    s_mov_b32 exec_hi, 0x10001
    buffer_store_dwordx4 v[184:187], v191, s[48:51], s78 offen sc1
    s_mov_b64 exec, -1
    s_barrier
    s_mov_b32 s40, s8
    s_and_b32 s41, s9, 0xffff
    s_mov_b32 s42, 524288
    s_mov_b32 s43, 0x20000
    v_lshlrev_b32 v18, 7, v0
    s_mul_i32 s64, s2, 7168
    s_lshl_b32 s65, s75, 12
    s_add_u32 s64, s64, s65
    s_bfm_b64 exec, 32, 0
    buffer_load_dword v122, v18, s[36:39], s64 offen
    s_lshl_b32 s64, s2, 11
    s_lshl_b32 s65, s75, 10
    s_add_u32 s64, s64, s65
    s_mov_b64 exec, 0xff
    buffer_load_dword v123, v18, s[40:43], s64 offen
    s_mov_b64 exec, -1
    v_and_b32 v18, 31, v0
    v_lshrrev_b32 v19, 5, v0
    v_lshlrev_b32 v19, 2, v19
    v_sub_u32 v18, v18, v19
    v_subrev_u32 v72, 0, v18
    v_ashrrev_i32 v88, 31, v72
    v_subrev_u32 v73, 1, v18
    v_ashrrev_i32 v89, 31, v73
    v_subrev_u32 v74, 2, v18
    v_ashrrev_i32 v90, 31, v74
    v_subrev_u32 v75, 3, v18
    v_ashrrev_i32 v91, 31, v75
    v_subrev_u32 v76, 8, v18
    v_ashrrev_i32 v92, 31, v76
    v_subrev_u32 v77, 9, v18
    v_ashrrev_i32 v93, 31, v77
    v_subrev_u32 v78, 10, v18
    v_ashrrev_i32 v94, 31, v78
    v_subrev_u32 v79, 11, v18
    v_ashrrev_i32 v95, 31, v79
    v_subrev_u32 v80, 16, v18
    v_ashrrev_i32 v96, 31, v80
    v_subrev_u32 v81, 17, v18
    v_ashrrev_i32 v97, 31, v81
    v_subrev_u32 v82, 18, v18
    v_ashrrev_i32 v98, 31, v82
    v_subrev_u32 v83, 19, v18
    v_ashrrev_i32 v99, 31, v83
    v_subrev_u32 v84, 24, v18
    v_ashrrev_i32 v100, 31, v84
    v_subrev_u32 v85, 25, v18
    v_ashrrev_i32 v101, 31, v85
    v_subrev_u32 v86, 26, v18
    v_ashrrev_i32 v102, 31, v86
    v_subrev_u32 v87, 27, v18
    v_ashrrev_i32 v103, 31, v87
    v_and_b32 v16, 0xffff, v88
    v_and_b32 v17, 0xffff0000, v89
    v_or_b32 v16, v16, v17
    v_not_b32 v104, v16
    v_and_b32 v16, 0xffff, v90
    v_and_b32 v17, 0xffff0000, v91
    v_or_b32 v16, v16, v17
    v_not_b32 v105, v16
    v_and_b32 v16, 0xffff, v92
    v_and_b32 v17, 0xffff0000, v93
    v_or_b32 v16, v16, v17
    v_not_b32 v106, v16
    v_and_b32 v16, 0xffff, v94
    v_and_b32 v17, 0xffff0000, v95
    v_or_b32 v16, v16, v17
    v_not_b32 v107, v16
    v_and_b32 v16, 0xffff, v96
    v_and_b32 v17, 0xffff0000, v97
    v_or_b32 v16, v16, v17
    v_not_b32 v108, v16
    v_and_b32 v16, 0xffff, v98
    v_and_b32 v17, 0xffff0000, v99
    v_or_b32 v16, v16, v17
    v_not_b32 v109, v16
    v_and_b32 v16, 0xffff, v100
    v_and_b32 v17, 0xffff0000, v101
    v_or_b32 v16, v16, v17
    v_not_b32 v110, v16
    v_and_b32 v16, 0xffff, v102
    v_and_b32 v17, 0xffff0000, v103
    v_or_b32 v16, v16, v17
    v_not_b32 v111, v16
    v_and_b32 v72, 0xff800000, v88
    v_xor_b32 v88, 0xff800000, v72
    v_and_b32 v73, 0xff800000, v89
    v_xor_b32 v89, 0xff800000, v73
    v_and_b32 v74, 0xff800000, v90
    v_xor_b32 v90, 0xff800000, v74
    v_and_b32 v75, 0xff800000, v91
    v_xor_b32 v91, 0xff800000, v75
    v_and_b32 v76, 0xff800000, v92
    v_xor_b32 v92, 0xff800000, v76
    v_and_b32 v77, 0xff800000, v93
    v_xor_b32 v93, 0xff800000, v77
    v_and_b32 v78, 0xff800000, v94
    v_xor_b32 v94, 0xff800000, v78
    v_and_b32 v79, 0xff800000, v95
    v_xor_b32 v95, 0xff800000, v79
    v_and_b32 v80, 0xff800000, v96
    v_xor_b32 v96, 0xff800000, v80
    v_and_b32 v81, 0xff800000, v97
    v_xor_b32 v97, 0xff800000, v81
    v_and_b32 v82, 0xff800000, v98
    v_xor_b32 v98, 0xff800000, v82
    v_and_b32 v83, 0xff800000, v99
    v_xor_b32 v99, 0xff800000, v83
    v_and_b32 v84, 0xff800000, v100
    v_xor_b32 v100, 0xff800000, v84
    v_and_b32 v85, 0xff800000, v101
    v_xor_b32 v101, 0xff800000, v85
    v_and_b32 v86, 0xff800000, v102
    v_xor_b32 v102, 0xff800000, v86
    v_and_b32 v87, 0xff800000, v103
    v_xor_b32 v103, 0xff800000, v87
    s_barrier
    v_lshlrev_b32 v10, 4, v0
    v_mov_b32 v14, 158720
    v_mov_b32 v15, 1
    s_and_b32 s64, s62, 1
    s_lshl_b32 s92, s58, 1
    s_add_u32 s92, s92, s64
    s_lshr_b32 s65, s62, 1
    s_lshl_b32 s93, s57, 2
    s_lshl_b32 s66, s65, 1
    s_add_u32 s93, s93, s66
    s_mul_i32 s95, s64, 12288
    s_add_u32 s95, s95, 131072
    s_lshl_b32 s22, s64, 16
    s_add_u32 s22, s22, 49152
    s_mov_b32 s94, 11526144
    s_lshl_b32 s66, s92, 16
    s_add_u32 s94, s94, s66
    s_lshl_b32 s67, s57, 12
    s_add_u32 s94, s94, s67
    s_lshl_b32 s65, s57, 2
    s_sub_u32 s65, s65, 8
    v_add_u32 v11, s65, v0
    v_lshlrev_b32 v11, 5, v11
    v_add_u32 v11, s58, v11
    v_lshlrev_b32 v11, 7, v11
    v_add_u32 v11, 15728640, v11
    s_lshl_b32 s65, s57, 2
    s_sub_i32 s65, 8, s65
    s_max_i32 s65, s65, 0
    s_lshl_b32 s10, 0xff, s65
    s_and_b32 s10, s10, 0xff
    s_mov_b32 s11, 0
    s_and_b32 s64, s62, 1
    s_mul_i32 s66, s64, 12288
    s_lshr_b32 s65, s62, 1
    s_lshl_b32 s65, s65, 11
    s_add_u32 s66, s66, s65
    s_add_u32 s66, s66, 131072
    v_add_u32 v12, s66, v10
    s_lshl_b32 s3, s64, 16
    s_add_u32 s3, s3, s65
    s_add_u32 s3, s3, 49152
    s_mul_i32 s96, s93, 147456
    s_lshl_b32 s64, s92, 10
    s_add_u32 s96, s96, s64
    s_add_u32 s96, s96, 114688
    s_lshl_b32 s97, s93, 5
    s_add_u32 s97, s97, s92
    s_lshl_b32 s97, s97, 7
    s_add_u32 s97, s97, 16515072
    s_add_u32 s23, s3, 12288
    v_add_u32 v13, s23, v10
    v_lshrrev_b32 v18, 5, v0
    v_lshlrev_b32 v22, 7, v18
    v_bfe_u32 v19, v0, 2, 2
    v_lshl_add_u32 v22, v19, 5, v22
    v_bfe_u32 v19, v0, 0, 1
    v_lshl_add_u32 v22, v19, 4, v22
    v_bfe_u32 v19, v0, 1, 1
    v_lshl_add_u32 v22, v19, 3, v22
    v_add_u32 v22, s3, v22
    v_xor_b32 v18, 1, v18
    v_lshlrev_b32 v18, 7, v18
    v_and_b32 v19, 15, v0
    v_lshl_add_u32 v18, v19, 3, v18
    v_add_u32 v18, 157696, v18
    v_bfe_u32 v19, v0, 4, 1
    v_cmp_eq_u32 vcc, 0, v19
    s_add_u32 s17, s93, 1
    s_min_u32 s17, s17, 9
    v_cndmask_b32 v22, v18, v22, vcc
    v_mov_b32 v18, 1024
    v_cndmask_b32 v21, 0, v18, vcc
    s_add_u32 s83, s93, 2
    s_min_u32 s83, s83, 9
    s_barrier
    s_barrier
    buffer_load_dwordx4 v[192:195], v188, s[48:51], s68 offen offset:0 sc1
    buffer_load_dwordx4 v[196:199], v188, s[48:51], s68 offen offset:1024 sc1
    buffer_load_dwordx4 v[200:203], v188, s[48:51], s68 offen offset:2048 sc1
    buffer_load_dwordx4 v[204:207], v188, s[48:51], s68 offen offset:3072 sc1
    buffer_load_dwordx4 v[208:211], v188, s[48:51], s69 offen offset:0 sc1
    buffer_load_dwordx4 v[212:215], v188, s[48:51], s69 offen offset:1024 sc1
    buffer_load_dwordx4 v[216:219], v188, s[48:51], s69 offen offset:2048 sc1
    buffer_load_dwordx4 v[220:223], v188, s[48:51], s69 offen offset:3072 sc1
    s_barrier
    s_barrier
    s_waitcnt vmcnt(0)
    s_mov_b32 s82, 0
L_ct_172:
    v_xor_b32 v18, s80, v193
    v_xor_b32 v19, s80, v195
    v_or_b32 v18, v18, v19
    v_xor_b32 v19, s80, v197
    v_or_b32 v18, v18, v19
    v_xor_b32 v19, s80, v199
    v_or_b32 v18, v18, v19
    v_xor_b32 v19, s80, v201
    v_or_b32 v18, v18, v19
    v_xor_b32 v19, s80, v203
    v_or_b32 v18, v18, v19
    v_xor_b32 v19, s80, v205
    v_or_b32 v18, v18, v19
    v_xor_b32 v19, s80, v207
    v_or_b32 v18, v18, v19
    v_xor_b32 v19, s80, v209
    v_or_b32 v18, v18, v19
    v_xor_b32 v19, s80, v211
    v_or_b32 v18, v18, v19
    v_xor_b32 v19, s80, v213
    v_or_b32 v18, v18, v19
    v_xor_b32 v19, s80, v215
    v_or_b32 v18, v18, v19
    v_xor_b32 v19, s80, v217
    v_or_b32 v18, v18, v19
    v_xor_b32 v19, s80, v219
    v_or_b32 v18, v18, v19
    v_xor_b32 v19, s80, v221
    v_or_b32 v18, v18, v19
    v_xor_b32 v19, s80, v223
    v_or_b32 v18, v18, v19
    v_cmp_ne_u32 vcc, 0, v18
    s_cbranch_vccz L_ck_171
    s_add_u32 s82, s82, 1
    s_cmp_gt_u32 s82, 60000
    s_cbranch_scc1 L_ck_171
    buffer_load_dwordx4 v[192:195], v188, s[48:51], s68 offen offset:0 sc1
    buffer_load_dwordx4 v[196:199], v188, s[48:51], s68 offen offset:1024 sc1
    buffer_load_dwordx4 v[200:203], v188, s[48:51], s68 offen offset:2048 sc1
    buffer_load_dwordx4 v[204:207], v188, s[48:51], s68 offen offset:3072 sc1
    buffer_load_dwordx4 v[208:211], v188, s[48:51], s69 offen offset:0 sc1
    buffer_load_dwordx4 v[212:215], v188, s[48:51], s69 offen offset:1024 sc1
    buffer_load_dwordx4 v[216:219], v188, s[48:51], s69 offen offset:2048 sc1
    buffer_load_dwordx4 v[220:223], v188, s[48:51], s69 offen offset:3072 sc1
    s_waitcnt vmcnt(0)
    s_branch L_ct_172
L_ck_171:
    v_add_f32 v192, v192, v196
    v_add_f32 v200, v200, v204
    v_add_f32 v192, v192, v200
    v_add_f32 v194, v194, v198
    v_add_f32 v202, v202, v206
    v_add_f32 v194, v194, v202
    s_nop 1
    v_permlane32_swap_b32 v192, v194
    v_add_f32 v192, v192, v194
    v_cvt_pk_bf16_f32 v18, v192, v192
    v_and_b32 v18, 0xffff0000, v18
    v_sub_f32 v19, v192, v18
    v_cvt_pk_bf16_f32 v18, v18, v19
    ds_write_b32 v189, v18 offset:0
    v_add_f32 v208, v208, v212
    v_add_f32 v216, v216, v220
    v_add_f32 v208, v208, v216
    v_add_f32 v210, v210, v214
    v_add_f32 v218, v218, v222
    v_add_f32 v210, v210, v218
    s_nop 1
    v_permlane32_swap_b32 v208, v210
    v_add_f32 v208, v208, v210
    v_cvt_pk_bf16_f32 v18, v208, v208
    v_and_b32 v18, 0xffff0000, v18
    v_sub_f32 v19, v208, v18
    v_cvt_pk_bf16_f32 v18, v18, v19
    ds_write_b32 v189, v18 offset:256
    s_waitcnt lgkmcnt(0)
    s_barrier
    v_lshrrev_b32 v18, 3, v0
    v_lshlrev_b32 v18, 10, v18
    v_and_b32 v19, 7, v0
    v_lshl_add_u32 v18, v19, 4, v18
    s_lshl_b32 s65, s60, 16
    s_lshl_b32 s66, s62, 14
    s_add_u32 s65, s65, s66
    s_lshl_b32 s66, s61, 7
    s_add_u32 s65, s65, s66
    buffer_load_dwordx4 v[248:251], v18, s[24:27], s65 offen
    s_add_u32 s65, s65, 8192
    buffer_load_dwordx4 v[252:255], v18, s[24:27], s65 offen
    s_and_b32 s78, s62, 1
    s_add_u32 s78, s78, s99
    s_add_u32 s78, s78, 0
    s_and_b32 s78, s78, 7
    s_mul_i32 s78, s78, 229376
    s_add_u32 s78, s78, s72
    s_add_u32 m0, s74, 32768
    s_add_u32 s79, s78, 0
    buffer_load_dwordx4 v5, s[32:35], s79 offen   lds
    s_add_u32 s79, s78, 27648
    buffer_load_dwordx4 v5, s[32:35], s79 offen offset:1024  lds
    s_add_u32 s79, s78, 55296
    buffer_load_dwordx4 v5, s[32:35], s79 offen offset:2048  lds
    s_add_u32 s79, s78, 82944
    buffer_load_dwordx4 v5, s[32:35], s79 offen offset:3072  lds
    s_add_u32 m0, s74, 36864
    s_add_u32 s79, s78, 114688
    buffer_load_dwordx4 v5, s[32:35], s79 offen   lds
    s_add_u32 s79, s78, 142336
    buffer_load_dwordx4 v5, s[32:35], s79 offen offset:1024  lds
    s_add_u32 s79, s78, 169984
    buffer_load_dwordx4 v5, s[32:35], s79 offen offset:2048  lds
    s_add_u32 s79, s78, 197632
    buffer_load_dwordx4 v5, s[32:35], s79 offen offset:3072  lds
    s_and_b32 s78, s62, 1
    s_add_u32 s78, s78, s99
    s_add_u32 s78, s78, 2
    s_and_b32 s78, s78, 7
    s_mul_i32 s78, s78, 229376
    s_add_u32 s78, s78, s72
    s_add_u32 m0, s74, 98304
    s_add_u32 s79, s78, 0
    buffer_load_dwordx4 v5, s[32:35], s79 offen   lds
    s_add_u32 s79, s78, 27648
    buffer_load_dwordx4 v5, s[32:35], s79 offen offset:1024  lds
    s_add_u32 s79, s78, 55296
    buffer_load_dwordx4 v5, s[32:35], s79 offen offset:2048  lds
    s_add_u32 s79, s78, 82944
    buffer_load_dwordx4 v5, s[32:35], s79 offen offset:3072  lds
    s_add_u32 m0, s74, 102400
    s_add_u32 s79, s78, 114688
    buffer_load_dwordx4 v5, s[32:35], s79 offen   lds
    s_add_u32 s79, s78, 142336
    buffer_load_dwordx4 v5, s[32:35], s79 offen offset:1024  lds
    s_add_u32 s79, s78, 169984
    buffer_load_dwordx4 v5, s[32:35], s79 offen offset:2048  lds
    s_add_u32 s79, s78, 197632
    buffer_load_dwordx4 v5, s[32:35], s79 offen offset:3072  lds
    s_barrier
    s_barrier
    s_and_b32 s78, s62, 1
    s_add_u32 s78, s78, s99
    s_add_u32 s78, s78, 4
    s_and_b32 s78, s78, 7
    s_mul_i32 s78, s78, 229376
    s_add_u32 s78, s78, s72
    s_add_u32 m0, s74, 0
    s_add_u32 s79, s78, 0
    buffer_load_dwordx4 v5, s[32:35], s79 offen   lds
    s_add_u32 s79, s78, 27648
    buffer_load_dwordx4 v5, s[32:35], s79 offen offset:1024  lds
    s_add_u32 s79, s78, 55296
    buffer_load_dwordx4 v5, s[32:35], s79 offen offset:2048  lds
    s_add_u32 s79, s78, 82944
    buffer_load_dwordx4 v5, s[32:35], s79 offen offset:3072  lds
    s_add_u32 m0, s74, 4096
    s_add_u32 s79, s78, 114688
    buffer_load_dwordx4 v5, s[32:35], s79 offen   lds
    s_add_u32 s79, s78, 142336
    buffer_load_dwordx4 v5, s[32:35], s79 offen offset:1024  lds
    s_add_u32 s79, s78, 169984
    buffer_load_dwordx4 v5, s[32:35], s79 offen offset:2048  lds
    s_add_u32 s79, s78, 197632
    buffer_load_dwordx4 v5, s[32:35], s79 offen offset:3072  lds
    s_and_b32 s78, s62, 1
    s_add_u32 s78, s78, s99
    s_add_u32 s78, s78, 6
    s_and_b32 s78, s78, 7
    s_mul_i32 s78, s78, 229376
    s_add_u32 s78, s78, s72
    s_add_u32 m0, s74, 65536
    s_add_u32 s79, s78, 0
    buffer_load_dwordx4 v5, s[32:35], s79 offen   lds
    s_add_u32 s79, s78, 27648
    buffer_load_dwordx4 v5, s[32:35], s79 offen offset:1024  lds
    s_add_u32 s79, s78, 55296
    buffer_load_dwordx4 v5, s[32:35], s79 offen offset:2048  lds
    s_add_u32 s79, s78, 82944
    buffer_load_dwordx4 v5, s[32:35], s79 offen offset:3072  lds
    s_add_u32 m0, s74, 69632
    s_add_u32 s79, s78, 114688
    buffer_load_dwordx4 v5, s[32:35], s79 offen   lds
    s_add_u32 s79, s78, 142336
    buffer_load_dwordx4 v5, s[32:35], s79 offen offset:1024  lds
    s_add_u32 s79, s78, 169984
    buffer_load_dwordx4 v5, s[32:35], s79 offen offset:2048  lds
    s_add_u32 s79, s78, 197632
    buffer_load_dwordx4 v5, s[32:35], s79 offen offset:3072  lds
    s_waitcnt vmcnt(16)
    s_mov_b64 exec, 1
    ds_add_u32 v14, v15 offset:16
    s_mov_b64 exec, -1
    s_waitcnt vmcnt(0)
    s_mov_b64 exec, 1
    ds_add_u32 v14, v15 offset:28
    s_mov_b64 exec, -1
    s_mov_b32 s82, 0
L_fa_173:
    ds_read_b32 v18, v14 offset:20
    s_add_u32 s82, s82, 1
    s_waitcnt lgkmcnt(0)
    v_readfirstlane_b32 s64, v18
    s_nop 0
    s_cmp_ge_u32 s64, 4
    s_cbranch_scc1 L_fad_174
    s_cmp_gt_u32 s82, 480000
    s_cbranch_scc1 L_fad_174
    s_sleep 2
    s_branch L_fa_173
L_fad_174:
    s_add_u32 m0, s74, 16384
    s_add_u32 s79, s73, 917504
    buffer_load_dwordx4 v6, s[36:39], s79 offen   lds
    s_add_u32 s79, s73, 924672
    buffer_load_dwordx4 v6, s[36:39], s79 offen offset:1024  lds
    s_add_u32 s79, s73, 931840
    buffer_load_dwordx4 v6, s[36:39], s79 offen offset:2048  lds
    s_add_u32 s79, s73, 939008
    buffer_load_dwordx4 v6, s[36:39], s79 offen offset:3072  lds
    s_add_u32 m0, s74, 20480
    s_add_u32 s79, s76, 917504
    buffer_load_dwordx4 v6, s[36:39], s79 offen   lds
    s_add_u32 s79, s76, 924672
    buffer_load_dwordx4 v6, s[36:39], s79 offen offset:1024  lds
    s_add_u32 s79, s76, 931840
    buffer_load_dwordx4 v6, s[36:39], s79 offen offset:2048  lds
    s_add_u32 s79, s76, 939008
    buffer_load_dwordx4 v6, s[36:39], s79 offen offset:3072  lds
    s_add_u32 m0, s74, 81920
    s_add_u32 s79, s73, 1376256
    buffer_load_dwordx4 v6, s[36:39], s79 offen   lds
    s_add_u32 s79, s73, 1383424
    buffer_load_dwordx4 v6, s[36:39], s79 offen offset:1024  lds
    s_add_u32 s79, s73, 1390592
    buffer_load_dwordx4 v6, s[36:39], s79 offen offset:2048  lds
    s_add_u32 s79, s73, 1397760
    buffer_load_dwordx4 v6, s[36:39], s79 offen offset:3072  lds
    s_add_u32 m0, s74, 86016
    s_add_u32 s79, s76, 1376256
    buffer_load_dwordx4 v6, s[36:39], s79 offen   lds
    s_add_u32 s79, s76, 1383424
    buffer_load_dwordx4 v6, s[36:39], s79 offen offset:1024  lds
    s_add_u32 s79, s76, 1390592
    buffer_load_dwordx4 v6, s[36:39], s79 offen offset:2048  lds
    s_add_u32 s79, s76, 1397760
    buffer_load_dwordx4 v6, s[36:39], s79 offen offset:3072  lds
L_rej_159:
    s_mov_b32 s82, 0
L_ow_175:
    ds_read_b32 v18, v14 offset:24
    s_add_u32 s82, s82, 1
    s_waitcnt lgkmcnt(0)
    v_readfirstlane_b32 s64, v18
    s_nop 0
    s_cmp_ge_u32 s64, 4
    s_cbranch_scc1 L_owd_176
    s_cmp_gt_u32 s82, 480000
    s_cbranch_scc1 L_owd_176
    s_sleep 2
    s_branch L_ow_175
L_owd_176:
    ds_read_b128 v[24:27], v13
    ds_read_b128 v[28:31], v13 offset:1024
    s_mov_b32 s82, 0
L_kc_177:
    ds_read_b32 v18, v14 offset:0
    s_add_u32 s82, s82, 1
    s_waitcnt lgkmcnt(0)
    v_readfirstlane_b32 s64, v18
    s_nop 0
    s_cmp_ge_u32 s64, 2
    s_cbranch_scc1 L_kcd_178
    s_cmp_gt_u32 s82, 480000
    s_cbranch_scc1 L_kcd_178
    s_sleep 2
    s_branch L_kc_177
L_kcd_178:
    s_setprio 2
    ds_read_b128 v[32:35], v12 offset:9216
    ds_read_b128 v[36:39], v12 offset:8192
    ds_read_b128 v[40:43], v12 offset:7168
    ds_read_b128 v[44:47], v12 offset:6144
    ds_read_b128 v[48:51], v12 offset:5120
    ds_read_b128 v[52:55], v12 offset:4096
    ds_read_b128 v[56:59], v12 offset:3072
    ds_read_b128 v[60:63], v12 offset:2048
    ds_read_b128 v[64:67], v12 offset:1024
    ds_read_b128 v[68:71], v12 offset:0
    s_waitcnt lgkmcnt(9)
    v_mfma_f32_32x32x16_bf16 v[128:143], v[32:35], v[28:31], v[72:87]
    s_waitcnt lgkmcnt(8)
    v_mfma_f32_32x32x16_bf16 v[144:159], v[36:39], v[24:27], v[72:87]
    s_waitcnt lgkmcnt(8)
    v_mfma_f32_32x32x16_bf16 v[160:175], v[36:39], v[28:31], 0
    s_nop 7
    v_max_f32 v23, v128, v129
    v_max3_f32 v23, v130, v131, v23
    v_max3_f32 v23, v132, v133, v23
    v_max3_f32 v23, v134, v135, v23
    v_max3_f32 v23, v136, v137, v23
    v_max3_f32 v23, v138, v139, v23
    v_max3_f32 v23, v140, v141, v23
    v_max3_f32 v23, v142, v143, v23
    s_waitcnt lgkmcnt(7)
    v_mfma_f32_32x32x16_bf16 v[128:143], v[40:43], v[24:27], 0
    v_max_f32 v16, v144, v145
    v_max3_f32 v16, v146, v147, v16
    v_max3_f32 v16, v148, v149, v16
    v_max3_f32 v16, v150, v151, v16
    v_max3_f32 v16, v152, v153, v16
    v_max3_f32 v16, v154, v155, v16
    v_max3_f32 v16, v156, v157, v16
    v_max3_f32 v16, v158, v159, v16
    s_waitcnt lgkmcnt(7)
    v_mfma_f32_32x32x16_bf16 v[144:159], v[40:43], v[28:31], 0
    s_cmp_le_u32 s83, 1
    s_cbranch_scc1 L_p1_179
    v_max3_f32 v23, v160, v161, v23
    v_max3_f32 v23, v162, v163, v23
    v_max3_f32 v23, v164, v165, v23
    v_max3_f32 v23, v166, v167, v23
    v_max3_f32 v23, v168, v169, v23
    v_max3_f32 v23, v170, v171, v23
    v_max3_f32 v23, v172, v173, v23
    v_max3_f32 v23, v174, v175, v23
    s_waitcnt lgkmcnt(6)
    v_mfma_f32_32x32x16_bf16 v[160:175], v[44:47], v[24:27], 0
    s_cmp_le_u32 s17, 1
    s_cbranch_scc1 L_p1_179
    v_max3_f32 v16, v128, v129, v16
    v_max3_f32 v16, v130, v131, v16
    v_max3_f32 v16, v132, v133, v16
    v_max3_f32 v16, v134, v135, v16
    v_max3_f32 v16, v136, v137, v16
    v_max3_f32 v16, v138, v139, v16
    v_max3_f32 v16, v140, v141, v16
    v_max3_f32 v16, v142, v143, v16
    s_waitcnt lgkmcnt(6)
    v_mfma_f32_32x32x16_bf16 v[128:143], v[44:47], v[28:31], 0
    s_cmp_le_u32 s83, 2
    s_cbranch_scc1 L_p1_179
    v_max3_f32 v23, v144, v145, v23
    v_max3_f32 v23, v146, v147, v23
    v_max3_f32 v23, v148, v149, v23
    v_max3_f32 v23, v150, v151, v23
    v_max3_f32 v23, v152, v153, v23
    v_max3_f32 v23, v154, v155, v23
    v_max3_f32 v23, v156, v157, v23
    v_max3_f32 v23, v158, v159, v23
    s_waitcnt lgkmcnt(5)
    v_mfma_f32_32x32x16_bf16 v[144:159], v[48:51], v[24:27], 0
    s_cmp_le_u32 s17, 2
    s_cbranch_scc1 L_p1_179
    v_max3_f32 v16, v160, v161, v16
    v_max3_f32 v16, v162, v163, v16
    v_max3_f32 v16, v164, v165, v16
    v_max3_f32 v16, v166, v167, v16
    v_max3_f32 v16, v168, v169, v16
    v_max3_f32 v16, v170, v171, v16
    v_max3_f32 v16, v172, v173, v16
    v_max3_f32 v16, v174, v175, v16
    s_waitcnt lgkmcnt(5)
    v_mfma_f32_32x32x16_bf16 v[160:175], v[48:51], v[28:31], 0
    s_cmp_le_u32 s83, 3
    s_cbranch_scc1 L_p1_179
    v_max3_f32 v23, v128, v129, v23
    v_max3_f32 v23, v130, v131, v23
    v_max3_f32 v23, v132, v133, v23
    v_max3_f32 v23, v134, v135, v23
    v_max3_f32 v23, v136, v137, v23
    v_max3_f32 v23, v138, v139, v23
    v_max3_f32 v23, v140, v141, v23
    v_max3_f32 v23, v142, v143, v23
    s_waitcnt lgkmcnt(4)
    v_mfma_f32_32x32x16_bf16 v[128:143], v[52:55], v[24:27], 0
    s_cmp_le_u32 s17, 3
    s_cbranch_scc1 L_p1_179
    v_max3_f32 v16, v144, v145, v16
    v_max3_f32 v16, v146, v147, v16
    v_max3_f32 v16, v148, v149, v16
    v_max3_f32 v16, v150, v151, v16
    v_max3_f32 v16, v152, v153, v16
    v_max3_f32 v16, v154, v155, v16
    v_max3_f32 v16, v156, v157, v16
    v_max3_f32 v16, v158, v159, v16
    s_waitcnt lgkmcnt(4)
    v_mfma_f32_32x32x16_bf16 v[144:159], v[52:55], v[28:31], 0
    s_cmp_le_u32 s83, 4
    s_cbranch_scc1 L_p1_179
    v_max3_f32 v23, v160, v161, v23
    v_max3_f32 v23, v162, v163, v23
    v_max3_f32 v23, v164, v165, v23
    v_max3_f32 v23, v166, v167, v23
    v_max3_f32 v23, v168, v169, v23
    v_max3_f32 v23, v170, v171, v23
    v_max3_f32 v23, v172, v173, v23
    v_max3_f32 v23, v174, v175, v23
    s_waitcnt lgkmcnt(3)
    v_mfma_f32_32x32x16_bf16 v[160:175], v[56:59], v[24:27], 0
    s_cmp_le_u32 s17, 4
    s_cbranch_scc1 L_p1_179
    v_max3_f32 v16, v128, v129, v16
    v_max3_f32 v16, v130, v131, v16
    v_max3_f32 v16, v132, v133, v16
    v_max3_f32 v16, v134, v135, v16
    v_max3_f32 v16, v136, v137, v16
    v_max3_f32 v16, v138, v139, v16
    v_max3_f32 v16, v140, v141, v16
    v_max3_f32 v16, v142, v143, v16
    s_waitcnt lgkmcnt(3)
    v_mfma_f32_32x32x16_bf16 v[128:143], v[56:59], v[28:31], 0
    s_cmp_le_u32 s83, 5
    s_cbranch_scc1 L_p1_179
    v_max3_f32 v23, v144, v145, v23
    v_max3_f32 v23, v146, v147, v23
    v_max3_f32 v23, v148, v149, v23
    v_max3_f32 v23, v150, v151, v23
    v_max3_f32 v23, v152, v153, v23
    v_max3_f32 v23, v154, v155, v23
    v_max3_f32 v23, v156, v157, v23
    v_max3_f32 v23, v158, v159, v23
    s_waitcnt lgkmcnt(2)
    v_mfma_f32_32x32x16_bf16 v[144:159], v[60:63], v[24:27], 0
    s_cmp_le_u32 s17, 5
    s_cbranch_scc1 L_p1_179
    v_max3_f32 v16, v160, v161, v16
    v_max3_f32 v16, v162, v163, v16
    v_max3_f32 v16, v164, v165, v16
    v_max3_f32 v16, v166, v167, v16
    v_max3_f32 v16, v168, v169, v16
    v_max3_f32 v16, v170, v171, v16
    v_max3_f32 v16, v172, v173, v16
    v_max3_f32 v16, v174, v175, v16
    s_waitcnt lgkmcnt(2)
    v_mfma_f32_32x32x16_bf16 v[160:175], v[60:63], v[28:31], 0
    s_cmp_le_u32 s83, 6
    s_cbranch_scc1 L_p1_179
    v_max3_f32 v23, v128, v129, v23
    v_max3_f32 v23, v130, v131, v23
    v_max3_f32 v23, v132, v133, v23
    v_max3_f32 v23, v134, v135, v23
    v_max3_f32 v23, v136, v137, v23
    v_max3_f32 v23, v138, v139, v23
    v_max3_f32 v23, v140, v141, v23
    v_max3_f32 v23, v142, v143, v23
    s_waitcnt lgkmcnt(1)
    v_mfma_f32_32x32x16_bf16 v[128:143], v[64:67], v[24:27], 0
    s_cmp_le_u32 s17, 6
    s_cbranch_scc1 L_p1_179
    v_max3_f32 v16, v144, v145, v16
    v_max3_f32 v16, v146, v147, v16
    v_max3_f32 v16, v148, v149, v16
    v_max3_f32 v16, v150, v151, v16
    v_max3_f32 v16, v152, v153, v16
    v_max3_f32 v16, v154, v155, v16
    v_max3_f32 v16, v156, v157, v16
    v_max3_f32 v16, v158, v159, v16
    s_waitcnt lgkmcnt(1)
    v_mfma_f32_32x32x16_bf16 v[144:159], v[64:67], v[28:31], v[88:103]
    s_cmp_le_u32 s83, 7
    s_cbranch_scc1 L_p1_179
    v_max3_f32 v23, v160, v161, v23
    v_max3_f32 v23, v162, v163, v23
    v_max3_f32 v23, v164, v165, v23
    v_max3_f32 v23, v166, v167, v23
    v_max3_f32 v23, v168, v169, v23
    v_max3_f32 v23, v170, v171, v23
    v_max3_f32 v23, v172, v173, v23
    v_max3_f32 v23, v174, v175, v23
    s_waitcnt lgkmcnt(0)
    v_mfma_f32_32x32x16_bf16 v[160:175], v[68:71], v[24:27], v[88:103]
    s_cmp_le_u32 s17, 7
    s_cbranch_scc1 L_p1_179
    v_max3_f32 v16, v128, v129, v16
    v_max3_f32 v16, v130, v131, v16
    v_max3_f32 v16, v132, v133, v16
    v_max3_f32 v16, v134, v135, v16
    v_max3_f32 v16, v136, v137, v16
    v_max3_f32 v16, v138, v139, v16
    v_max3_f32 v16, v140, v141, v16
    v_max3_f32 v16, v142, v143, v16
    s_cmp_le_u32 s83, 8
    s_cbranch_scc1 L_p1_179
    v_max3_f32 v23, v144, v145, v23
    v_max3_f32 v23, v146, v147, v23
    v_max3_f32 v23, v148, v149, v23
    v_max3_f32 v23, v150, v151, v23
    v_max3_f32 v23, v152, v153, v23
    v_max3_f32 v23, v154, v155, v23
    v_max3_f32 v23, v156, v157, v23
    v_max3_f32 v23, v158, v159, v23
    s_cmp_le_u32 s17, 8
    s_cbranch_scc1 L_p1_179
    v_max3_f32 v16, v160, v161, v16
    v_max3_f32 v16, v162, v163, v16
    v_max3_f32 v16, v164, v165, v16
    v_max3_f32 v16, v166, v167, v16
    v_max3_f32 v16, v168, v169, v16
    v_max3_f32 v16, v170, v171, v16
    v_max3_f32 v16, v172, v173, v16
    v_max3_f32 v16, v174, v175, v16
L_p1_179:
    s_waitcnt lgkmcnt(0)
    s_cmp_lt_u32 s62, 2
    s_cbranch_scc1 L_r01_180
    s_mov_b32 s82, 0
L_fr_181:
    ds_read_b32 v18, v14 offset:12
    s_add_u32 s82, s82, 1
    s_waitcnt lgkmcnt(0)
    v_readfirstlane_b32 s64, v18
    s_nop 0
    s_cmp_ge_u32 s64, 4
    s_cbranch_scc1 L_frd_182
    s_cmp_gt_u32 s82, 480000
    s_cbranch_scc1 L_frd_182
    s_sleep 2
    s_branch L_fr_181
L_frd_182:
    s_add_u32 m0, s74, 32768
    s_add_u32 s79, s73, 0
    buffer_load_dwordx4 v6, s[36:39], s79 offen   lds
    s_add_u32 s79, s73, 7168
    buffer_load_dwordx4 v6, s[36:39], s79 offen offset:1024  lds
    s_add_u32 s79, s73, 14336
    buffer_load_dwordx4 v6, s[36:39], s79 offen offset:2048  lds
    s_add_u32 s79, s73, 21504
    buffer_load_dwordx4 v6, s[36:39], s79 offen offset:3072  lds
    s_add_u32 m0, s74, 36864
    s_add_u32 s79, s76, 0
    buffer_load_dwordx4 v6, s[36:39], s79 offen   lds
    s_add_u32 s79, s76, 7168
    buffer_load_dwordx4 v6, s[36:39], s79 offen offset:1024  lds
    s_add_u32 s79, s76, 14336
    buffer_load_dwordx4 v6, s[36:39], s79 offen offset:2048  lds
    s_add_u32 s79, s76, 21504
    buffer_load_dwordx4 v6, s[36:39], s79 offen offset:3072  lds
    s_add_u32 m0, s74, 98304
    s_add_u32 s79, s73, 458752
    buffer_load_dwordx4 v6, s[36:39], s79 offen   lds
    s_add_u32 s79, s73, 465920
    buffer_load_dwordx4 v6, s[36:39], s79 offen offset:1024  lds
    s_add_u32 s79, s73, 473088
    buffer_load_dwordx4 v6, s[36:39], s79 offen offset:2048  lds
    s_add_u32 s79, s73, 480256
    buffer_load_dwordx4 v6, s[36:39], s79 offen offset:3072  lds
    s_add_u32 m0, s74, 102400
    s_add_u32 s79, s76, 458752
    buffer_load_dwordx4 v6, s[36:39], s79 offen   lds
    s_add_u32 s79, s76, 465920
    buffer_load_dwordx4 v6, s[36:39], s79 offen offset:1024  lds
    s_add_u32 s79, s76, 473088
    buffer_load_dwordx4 v6, s[36:39], s79 offen offset:2048  lds
    s_add_u32 s79, s76, 480256
    buffer_load_dwordx4 v6, s[36:39], s79 offen offset:3072  lds
L_r01_180:
    v_mov_b32 v17, v16
    s_nop 1
    v_permlane32_swap_b32 v16, v17
    v_max_f32 v16, v16, v17
    v_sub_f32 v112, 0, v16
    v_sub_f32 v113, 0, v16
    v_sub_f32 v114, 0, v16
    v_sub_f32 v115, 0, v16
    v_sub_f32 v116, 0, v16
    v_sub_f32 v117, 0, v16
    v_sub_f32 v118, 0, v16
    v_sub_f32 v119, 0, v16
    v_sub_f32 v120, 0, v16
    v_sub_f32 v121, 0, v16
    v_sub_f32 v122, 0, v16
    v_sub_f32 v123, 0, v16
    v_sub_f32 v124, 0, v16
    v_sub_f32 v125, 0, v16
    v_sub_f32 v126, 0, v16
    v_sub_f32 v127, 0, v16
    v_mov_b32 v17, v23
    s_nop 1
    v_permlane32_swap_b32 v23, v17
    v_max_f32 v23, v23, v17
    v_sub_f32 v224, 0, v23
    v_sub_f32 v225, 0, v23
    v_sub_f32 v226, 0, v23
    v_sub_f32 v227, 0, v23
    v_sub_f32 v228, 0, v23
    v_sub_f32 v229, 0, v23
    v_sub_f32 v230, 0, v23
    v_sub_f32 v231, 0, v23
    v_sub_f32 v232, 0, v23
    v_sub_f32 v233, 0, v23
    v_sub_f32 v234, 0, v23
    v_sub_f32 v235, 0, v23
    v_sub_f32 v236, 0, v23
    v_sub_f32 v237, 0, v23
    v_sub_f32 v238, 0, v23
    v_sub_f32 v239, 0, v23
    s_mov_b64 exec, 1
    ds_add_u32 v14, v15 offset:4
    s_mov_b64 exec, -1
    s_mov_b32 s77, 0
    s_cmp_ge_u32 s62, 2
    s_cbranch_scc1 L_va_183
    s_waitcnt vmcnt(0)
    s_mov_b64 exec, 1
    ds_add_u32 v14, v15 offset:0
    s_mov_b64 exec, -1
    s_mov_b32 s77, 1
L_va_183:
    s_mov_b32 s82, 0
L_vc_184:
    ds_read_b32 v18, v14 offset:0
    s_add_u32 s82, s82, 1
    s_waitcnt lgkmcnt(0)
    v_readfirstlane_b32 s64, v18
    s_nop 0
    s_cmp_ge_u32 s64, 4
    s_cbranch_scc1 L_vcd_185
    s_cmp_gt_u32 s82, 480000
    s_cbranch_scc1 L_vcd_185
    s_sleep 2
    s_branch L_vc_184
L_vcd_185:
    v_mfma_f32_32x32x16_bf16 v[128:143], v[36:39], v[24:27], v[112:127]
    v_mul_u32_u24 v20, 8, v21
    v_add_u32 v20, v20, v22
    v_mov_b32 v176, 0
    v_mov_b32 v177, 0
    v_mov_b32 v178, 0
    v_mov_b32 v179, 0
    v_mov_b32 v180, 0
    v_mov_b32 v181, 0
    v_mov_b32 v182, 0
    v_mov_b32 v183, 0
    v_mov_b32 v184, 0
    v_mfma_f32_32x32x16_bf16 v[144:159], v[40:43], v[24:27], v[112:127]
    ds_read_b64_tr_b16 v[192:193], v20 offset:0
    ds_read_b64_tr_b16 v[194:195], v20 offset:256
    ds_read_b64_tr_b16 v[196:197], v20 offset:512
    ds_read_b64_tr_b16 v[198:199], v20 offset:768
    v_sub_u32 v20, v20, v21
    v_exp_f32 v128, v128
    v_exp_f32 v129, v129
    v_exp_f32 v130, v130
    v_exp_f32 v131, v131
    v_exp_f32 v132, v132
    v_exp_f32 v133, v133
    v_exp_f32 v134, v134
    v_exp_f32 v135, v135
    v_exp_f32 v136, v136
    v_exp_f32 v137, v137
    v_exp_f32 v138, v138
    v_exp_f32 v139, v139
    v_exp_f32 v140, v140
    v_exp_f32 v141, v141
    v_exp_f32 v142, v142
    v_exp_f32 v143, v143
    v_cvt_pk_bf16_f32 v208, v128, v129
    v_cvt_pk_bf16_f32 v209, v130, v131
    v_cvt_pk_bf16_f32 v210, v132, v133
    v_cvt_pk_bf16_f32 v211, v134, v135
    v_cvt_pk_bf16_f32 v212, v136, v137
    v_cvt_pk_bf16_f32 v213, v138, v139
    v_cvt_pk_bf16_f32 v214, v140, v141
    v_cvt_pk_bf16_f32 v215, v142, v143
    v_and_b32 v208, v208, v104
    v_and_b32 v209, v209, v105
    v_and_b32 v210, v210, v106
    v_and_b32 v211, v211, v107
    v_and_b32 v212, v212, v108
    v_and_b32 v213, v213, v109
    v_and_b32 v214, v214, v110
    v_and_b32 v215, v215, v111
    s_cmp_le_u32 s17, 1
    s_cbranch_scc1 L_t0_186
    v_mfma_f32_32x32x16_bf16 v[128:143], v[44:47], v[24:27], v[112:127]
    s_getreg_b32 s64, hwreg(HW_REG_IB_STS)
    s_and_b32 s64, s64, 0xc0000f
    s_or_b32 s64, s64, s77
    s_cbranch_scc0 L_ht_189
L_htr_190:
    ds_read_b64_tr_b16 v[200:201], v20 offset:0
    ds_read_b64_tr_b16 v[202:203], v20 offset:256
    ds_read_b64_tr_b16 v[204:205], v20 offset:512
    ds_read_b64_tr_b16 v[206:207], v20 offset:768
    v_sub_u32 v20, v20, v21
    v_exp_f32 v144, v144
    v_exp_f32 v145, v145
    v_exp_f32 v146, v146
    v_exp_f32 v147, v147
    v_exp_f32 v148, v148
    s_waitcnt lgkmcnt(4)
    v_mfma_f32_32x32x16_bf16 v[176:191], v[192:195], v[208:211], v[176:191]
    v_exp_f32 v149, v149
    v_exp_f32 v150, v150
    v_exp_f32 v151, v151
    v_exp_f32 v152, v152
    v_exp_f32 v153, v153
    v_mfma_f32_32x32x16_bf16 v[176:191], v[196:199], v[212:215], v[176:191]
    v_exp_f32 v154, v154
    v_exp_f32 v155, v155
    v_exp_f32 v156, v156
    v_exp_f32 v157, v157
    v_exp_f32 v158, v158
    v_exp_f32 v159, v159
    v_cvt_pk_bf16_f32 v216, v144, v145
    v_cvt_pk_bf16_f32 v217, v146, v147
    v_cvt_pk_bf16_f32 v218, v148, v149
    v_cvt_pk_bf16_f32 v219, v150, v151
    v_cvt_pk_bf16_f32 v220, v152, v153
    v_cvt_pk_bf16_f32 v221, v154, v155
    v_cvt_pk_bf16_f32 v222, v156, v157
    v_cvt_pk_bf16_f32 v223, v158, v159
    s_cmp_le_u32 s17, 2
    s_cbranch_scc1 L_t1_187
    v_mfma_f32_32x32x16_bf16 v[144:159], v[48:51], v[24:27], v[112:127]
    s_getreg_b32 s64, hwreg(HW_REG_IB_STS)
    s_and_b32 s64, s64, 0xc0000f
    s_or_b32 s64, s64, s77
    s_cbranch_scc0 L_ht_191
L_htr_192:
    ds_read_b64_tr_b16 v[192:193], v20 offset:0
    ds_read_b64_tr_b16 v[194:195], v20 offset:256
    ds_read_b64_tr_b16 v[196:197], v20 offset:512
    ds_read_b64_tr_b16 v[198:199], v20 offset:768
    v_sub_u32 v20, v20, v21
    v_exp_f32 v128, v128
    v_exp_f32 v129, v129
    v_exp_f32 v130, v130
    v_exp_f32 v131, v131
    v_exp_f32 v132, v132
    s_waitcnt lgkmcnt(4)
    v_mfma_f32_32x32x16_bf16 v[176:191], v[200:203], v[216:219], v[176:191]
    v_exp_f32 v133, v133
    v_exp_f32 v134, v134
    v_exp_f32 v135, v135
    v_exp_f32 v136, v136
    v_exp_f32 v137, v137
    v_mfma_f32_32x32x16_bf16 v[176:191], v[204:207], v[220:223], v[176:191]
    v_exp_f32 v138, v138
    v_exp_f32 v139, v139
    v_exp_f32 v140, v140
    v_exp_f32 v141, v141
    v_exp_f32 v142, v142
    v_exp_f32 v143, v143
    v_cvt_pk_bf16_f32 v208, v128, v129
    v_cvt_pk_bf16_f32 v209, v130, v131
    v_cvt_pk_bf16_f32 v210, v132, v133
    v_cvt_pk_bf16_f32 v211, v134, v135
    v_cvt_pk_bf16_f32 v212, v136, v137
    v_cvt_pk_bf16_f32 v213, v138, v139
    v_cvt_pk_bf16_f32 v214, v140, v141
    v_cvt_pk_bf16_f32 v215, v142, v143
    s_cmp_le_u32 s17, 3
    s_cbranch_scc1 L_t0_186
    v_mfma_f32_32x32x16_bf16 v[128:143], v[52:55], v[24:27], v[112:127]
    s_getreg_b32 s64, hwreg(HW_REG_IB_STS)
    s_and_b32 s64, s64, 0xc0000f
    s_or_b32 s64, s64, s77
    s_cbranch_scc0 L_ht_193
L_htr_194:
    ds_read_b64_tr_b16 v[200:201], v20 offset:0
    ds_read_b64_tr_b16 v[202:203], v20 offset:256
    ds_read_b64_tr_b16 v[204:205], v20 offset:512
    ds_read_b64_tr_b16 v[206:207], v20 offset:768
    v_sub_u32 v20, v20, v21
    v_exp_f32 v144, v144
    v_exp_f32 v145, v145
    v_exp_f32 v146, v146
    v_exp_f32 v147, v147
    v_exp_f32 v148, v148
    s_waitcnt lgkmcnt(4)
    v_mfma_f32_32x32x16_bf16 v[176:191], v[192:195], v[208:211], v[176:191]
    v_exp_f32 v149, v149
    v_exp_f32 v150, v150
    v_exp_f32 v151, v151
    v_exp_f32 v152, v152
    v_exp_f32 v153, v153
    v_mfma_f32_32x32x16_bf16 v[176:191], v[196:199], v[212:215], v[176:191]
    v_exp_f32 v154, v154
    v_exp_f32 v155, v155
    v_exp_f32 v156, v156
    v_exp_f32 v157, v157
    v_exp_f32 v158, v158
    v_exp_f32 v159, v159
    v_cvt_pk_bf16_f32 v216, v144, v145
    v_cvt_pk_bf16_f32 v217, v146, v147
    v_cvt_pk_bf16_f32 v218, v148, v149
    v_cvt_pk_bf16_f32 v219, v150, v151
    v_cvt_pk_bf16_f32 v220, v152, v153
    v_cvt_pk_bf16_f32 v221, v154, v155
    v_cvt_pk_bf16_f32 v222, v156, v157
    v_cvt_pk_bf16_f32 v223, v158, v159
    s_cmp_le_u32 s17, 4
    s_cbranch_scc1 L_t1_187
    v_mfma_f32_32x32x16_bf16 v[144:159], v[56:59], v[24:27], v[112:127]
    s_getreg_b32 s64, hwreg(HW_REG_IB_STS)
    s_and_b32 s64, s64, 0xc0000f
    s_or_b32 s64, s64, s77
    s_cbranch_scc0 L_ht_195
L_htr_196:
    ds_read_b64_tr_b16 v[192:193], v20 offset:0
    ds_read_b64_tr_b16 v[194:195], v20 offset:256
    ds_read_b64_tr_b16 v[196:197], v20 offset:512
    ds_read_b64_tr_b16 v[198:199], v20 offset:768
    v_sub_u32 v20, v20, v21
    v_exp_f32 v128, v128
    v_exp_f32 v129, v129
    v_exp_f32 v130, v130
    v_exp_f32 v131, v131
    v_exp_f32 v132, v132
    s_waitcnt lgkmcnt(4)
    v_mfma_f32_32x32x16_bf16 v[176:191], v[200:203], v[216:219], v[176:191]
    v_exp_f32 v133, v133
    v_exp_f32 v134, v134
    v_exp_f32 v135, v135
    v_exp_f32 v136, v136
    v_exp_f32 v137, v137
    v_mfma_f32_32x32x16_bf16 v[176:191], v[204:207], v[220:223], v[176:191]
    v_exp_f32 v138, v138
    v_exp_f32 v139, v139
    v_exp_f32 v140, v140
    v_exp_f32 v141, v141
    v_exp_f32 v142, v142
    v_exp_f32 v143, v143
    v_cvt_pk_bf16_f32 v208, v128, v129
    v_cvt_pk_bf16_f32 v209, v130, v131
    v_cvt_pk_bf16_f32 v210, v132, v133
    v_cvt_pk_bf16_f32 v211, v134, v135
    v_cvt_pk_bf16_f32 v212, v136, v137
    v_cvt_pk_bf16_f32 v213, v138, v139
    v_cvt_pk_bf16_f32 v214, v140, v141
    v_cvt_pk_bf16_f32 v215, v142, v143
    s_cmp_le_u32 s17, 5
    s_cbranch_scc1 L_t0_186
    v_mfma_f32_32x32x16_bf16 v[128:143], v[60:63], v[24:27], v[112:127]
    ds_read_b64_tr_b16 v[200:201], v20 offset:0
    ds_read_b64_tr_b16 v[202:203], v20 offset:256
    ds_read_b64_tr_b16 v[204:205], v20 offset:512
    ds_read_b64_tr_b16 v[206:207], v20 offset:768
    v_sub_u32 v20, v20, v21
    v_exp_f32 v144, v144
    v_exp_f32 v145, v145
    v_exp_f32 v146, v146
    v_exp_f32 v147, v147
    v_exp_f32 v148, v148
    s_waitcnt lgkmcnt(4)
    v_mfma_f32_32x32x16_bf16 v[176:191], v[192:195], v[208:211], v[176:191]
    v_exp_f32 v149, v149
    v_exp_f32 v150, v150
    v_exp_f32 v151, v151
    v_exp_f32 v152, v152
    v_exp_f32 v153, v153
    v_mfma_f32_32x32x16_bf16 v[176:191], v[196:199], v[212:215], v[176:191]
    v_exp_f32 v154, v154
    v_exp_f32 v155, v155
    v_exp_f32 v156, v156
    v_exp_f32 v157, v157
    v_exp_f32 v158, v158
    v_exp_f32 v159, v159
    v_cvt_pk_bf16_f32 v216, v144, v145
    v_cvt_pk_bf16_f32 v217, v146, v147
    v_cvt_pk_bf16_f32 v218, v148, v149
    v_cvt_pk_bf16_f32 v219, v150, v151
    v_cvt_pk_bf16_f32 v220, v152, v153
    v_cvt_pk_bf16_f32 v221, v154, v155
    v_cvt_pk_bf16_f32 v222, v156, v157
    v_cvt_pk_bf16_f32 v223, v158, v159
    s_cmp_le_u32 s17, 6
    s_cbranch_scc1 L_t1_187
    v_mfma_f32_32x32x16_bf16 v[144:159], v[64:67], v[24:27], v[112:127]
    s_getreg_b32 s64, hwreg(HW_REG_IB_STS)
    s_and_b32 s64, s64, 0xc0000f
    s_or_b32 s64, s64, s77
    s_cbranch_scc0 L_ht_197
L_htr_198:
    ds_read_b64_tr_b16 v[192:193], v20 offset:0
    ds_read_b64_tr_b16 v[194:195], v20 offset:256
    ds_read_b64_tr_b16 v[196:197], v20 offset:512
    ds_read_b64_tr_b16 v[198:199], v20 offset:768
    v_sub_u32 v20, v20, v21
    v_exp_f32 v128, v128
    v_exp_f32 v129, v129
    v_exp_f32 v130, v130
    v_exp_f32 v131, v131
    v_exp_f32 v132, v132
    s_waitcnt lgkmcnt(4)
    v_mfma_f32_32x32x16_bf16 v[176:191], v[200:203], v[216:219], v[176:191]
    v_exp_f32 v133, v133
    v_exp_f32 v134, v134
    v_exp_f32 v135, v135
    v_exp_f32 v136, v136
    v_exp_f32 v137, v137
    v_mfma_f32_32x32x16_bf16 v[176:191], v[204:207], v[220:223], v[176:191]
    v_exp_f32 v138, v138
    v_exp_f32 v139, v139
    v_exp_f32 v140, v140
    v_exp_f32 v141, v141
    v_exp_f32 v142, v142
    v_exp_f32 v143, v143
    v_cvt_pk_bf16_f32 v208, v128, v129
    v_cvt_pk_bf16_f32 v209, v130, v131
    v_cvt_pk_bf16_f32 v210, v132, v133
    v_cvt_pk_bf16_f32 v211, v134, v135
    v_cvt_pk_bf16_f32 v212, v136, v137
    v_cvt_pk_bf16_f32 v213, v138, v139
    v_cvt_pk_bf16_f32 v214, v140, v141
    v_cvt_pk_bf16_f32 v215, v142, v143
    s_cmp_le_u32 s17, 7
    s_cbranch_scc1 L_t0_186
    v_mfma_f32_32x32x16_bf16 v[128:143], v[68:71], v[24:27], v[112:127]
    ds_read_b64_tr_b16 v[200:201], v20 offset:0
    ds_read_b64_tr_b16 v[202:203], v20 offset:256
    ds_read_b64_tr_b16 v[204:205], v20 offset:512
    ds_read_b64_tr_b16 v[206:207], v20 offset:768
    v_sub_u32 v20, v20, v21
    v_exp_f32 v144, v144
    v_exp_f32 v145, v145
    v_exp_f32 v146, v146
    v_exp_f32 v147, v147
    v_exp_f32 v148, v148
    s_waitcnt lgkmcnt(4)
    v_mfma_f32_32x32x16_bf16 v[176:191], v[192:195], v[208:211], v[176:191]
    v_exp_f32 v149, v149
    v_exp_f32 v150, v150
    v_exp_f32 v151, v151
    v_exp_f32 v152, v152
    v_exp_f32 v153, v153
    v_mfma_f32_32x32x16_bf16 v[176:191], v[196:199], v[212:215], v[176:191]
    v_exp_f32 v154, v154
    v_exp_f32 v155, v155
    v_exp_f32 v156, v156
    v_exp_f32 v157, v157
    v_exp_f32 v158, v158
    v_exp_f32 v159, v159
    v_cvt_pk_bf16_f32 v216, v144, v145
    v_cvt_pk_bf16_f32 v217, v146, v147
    v_cvt_pk_bf16_f32 v218, v148, v149
    v_cvt_pk_bf16_f32 v219, v150, v151
    v_cvt_pk_bf16_f32 v220, v152, v153
    v_cvt_pk_bf16_f32 v221, v154, v155
    v_cvt_pk_bf16_f32 v222, v156, v157
    v_cvt_pk_bf16_f32 v223, v158, v159
    s_cmp_le_u32 s17, 8
    s_cbranch_scc1 L_t1_187
    s_getreg_b32 s64, hwreg(HW_REG_IB_STS)
    s_and_b32 s64, s64, 0xc0000f
    s_or_b32 s64, s64, s77
    s_cbranch_scc0 L_ht_199
L_htr_200:
    ds_read_b64_tr_b16 v[192:193], v20 offset:0
    ds_read_b64_tr_b16 v[194:195], v20 offset:256
    ds_read_b64_tr_b16 v[196:197], v20 offset:512
    ds_read_b64_tr_b16 v[198:199], v20 offset:768
    v_sub_u32 v20, v20, v21
    v_exp_f32 v128, v128
    v_exp_f32 v129, v129
    v_exp_f32 v130, v130
    v_exp_f32 v131, v131
    v_exp_f32 v132, v132
    s_waitcnt lgkmcnt(4)
    v_mfma_f32_32x32x16_bf16 v[176:191], v[200:203], v[216:219], v[176:191]
    v_exp_f32 v133, v133
    v_exp_f32 v134, v134
    v_exp_f32 v135, v135
    v_exp_f32 v136, v136
    v_exp_f32 v137, v137
    v_mfma_f32_32x32x16_bf16 v[176:191], v[204:207], v[220:223], v[176:191]
    v_exp_f32 v138, v138
    v_exp_f32 v139, v139
    v_exp_f32 v140, v140
    v_exp_f32 v141, v141
    v_exp_f32 v142, v142
    v_exp_f32 v143, v143
    v_cvt_pk_bf16_f32 v208, v128, v129
    v_cvt_pk_bf16_f32 v209, v130, v131
    v_cvt_pk_bf16_f32 v210, v132, v133
    v_cvt_pk_bf16_f32 v211, v134, v135
    v_cvt_pk_bf16_f32 v212, v136, v137
    v_cvt_pk_bf16_f32 v213, v138, v139
    v_cvt_pk_bf16_f32 v214, v140, v141
    v_cvt_pk_bf16_f32 v215, v142, v143
    v_bfi_b32 v208, v104, 0, v208
    v_bfi_b32 v209, v105, 0, v209
    v_bfi_b32 v210, v106, 0, v210
    v_bfi_b32 v211, v107, 0, v211
    v_bfi_b32 v212, v108, 0, v212
    v_bfi_b32 v213, v109, 0, v213
    v_bfi_b32 v214, v110, 0, v214
    v_bfi_b32 v215, v111, 0, v215
L_t0_186:
    s_waitcnt lgkmcnt(0)
    s_nop 1
    v_mfma_f32_32x32x16_bf16 v[176:191], v[192:195], v[208:211], v[176:191]
    v_mfma_f32_32x32x16_bf16 v[176:191], v[196:199], v[212:215], v[176:191]
    s_branch L_fin_188
L_t1_187:
    s_waitcnt lgkmcnt(0)
    s_nop 1
    v_mfma_f32_32x32x16_bf16 v[176:191], v[200:203], v[216:219], v[176:191]
    v_mfma_f32_32x32x16_bf16 v[176:191], v[204:207], v[220:223], v[176:191]
L_fin_188:
    s_nop 11
    v_rcp_f32 v17, v184
    s_nop 0
    v_mul_f32 v176, v176, v17
    v_mul_f32 v177, v177, v17
    v_mul_f32 v178, v178, v17
    v_mul_f32 v179, v179, v17
    v_mul_f32 v180, v180, v17
    v_mul_f32 v181, v181, v17
    v_mul_f32 v182, v182, v17
    v_mul_f32 v183, v183, v17
    v_cvt_pk_bf16_f32 v240, v176, v177
    v_cvt_pk_bf16_f32 v241, v178, v179
    v_cvt_pk_bf16_f32 v242, v180, v181
    v_cvt_pk_bf16_f32 v243, v182, v183
    s_cmp_eq_u32 s77, 0
    s_cbranch_scc1 L_ht_201
L_htr_202:
    s_add_u32 s64, s96, 0
    s_mov_b32 s77, 0
    buffer_store_dwordx4 v[240:243], v10, s[48:51], s64 offen sc1
    v_mfma_f32_32x32x16_bf16 v[128:143], v[32:35], v[28:31], v[224:239]
    v_mul_u32_u24 v20, 9, v21
    v_add_u32 v20, v20, v22
    v_mov_b32 v176, 0
    v_mov_b32 v177, 0
    v_mov_b32 v178, 0
    v_mov_b32 v179, 0
    v_mov_b32 v180, 0
    v_mov_b32 v181, 0
    v_mov_b32 v182, 0
    v_mov_b32 v183, 0
    v_mov_b32 v184, 0
    v_mfma_f32_32x32x16_bf16 v[144:159], v[36:39], v[28:31], v[224:239]
    ds_read_b64_tr_b16 v[192:193], v20 offset:0
    ds_read_b64_tr_b16 v[194:195], v20 offset:256
    ds_read_b64_tr_b16 v[196:197], v20 offset:512
    ds_read_b64_tr_b16 v[198:199], v20 offset:768
    v_sub_u32 v20, v20, v21
    v_exp_f32 v128, v128
    v_exp_f32 v129, v129
    v_exp_f32 v130, v130
    v_exp_f32 v131, v131
    v_exp_f32 v132, v132
    v_exp_f32 v133, v133
    v_exp_f32 v134, v134
    v_exp_f32 v135, v135
    v_exp_f32 v136, v136
    v_exp_f32 v137, v137
    v_exp_f32 v138, v138
    v_exp_f32 v139, v139
    v_exp_f32 v140, v140
    v_exp_f32 v141, v141
    v_exp_f32 v142, v142
    v_exp_f32 v143, v143
    v_cvt_pk_bf16_f32 v208, v128, v129
    v_cvt_pk_bf16_f32 v209, v130, v131
    v_cvt_pk_bf16_f32 v210, v132, v133
    v_cvt_pk_bf16_f32 v211, v134, v135
    v_cvt_pk_bf16_f32 v212, v136, v137
    v_cvt_pk_bf16_f32 v213, v138, v139
    v_cvt_pk_bf16_f32 v214, v140, v141
    v_cvt_pk_bf16_f32 v215, v142, v143
    v_and_b32 v208, v208, v104
    v_and_b32 v209, v209, v105
    v_and_b32 v210, v210, v106
    v_and_b32 v211, v211, v107
    v_and_b32 v212, v212, v108
    v_and_b32 v213, v213, v109
    v_and_b32 v214, v214, v110
    v_and_b32 v215, v215, v111
    s_cmp_le_u32 s83, 1
    s_cbranch_scc1 L_t0_203
    v_mfma_f32_32x32x16_bf16 v[128:143], v[40:43], v[28:31], v[224:239]
    s_getreg_b32 s64, hwreg(HW_REG_IB_STS)
    s_and_b32 s64, s64, 0xc0000f
    s_or_b32 s64, s64, s77
    s_cbranch_scc0 L_ht_206
L_htr_207:
    ds_read_b64_tr_b16 v[200:201], v20 offset:0
    ds_read_b64_tr_b16 v[202:203], v20 offset:256
    ds_read_b64_tr_b16 v[204:205], v20 offset:512
    ds_read_b64_tr_b16 v[206:207], v20 offset:768
    v_sub_u32 v20, v20, v21
    v_exp_f32 v144, v144
    v_exp_f32 v145, v145
    v_exp_f32 v146, v146
    v_exp_f32 v147, v147
    v_exp_f32 v148, v148
    s_waitcnt lgkmcnt(4)
    v_mfma_f32_32x32x16_bf16 v[176:191], v[192:195], v[208:211], v[176:191]
    v_exp_f32 v149, v149
    v_exp_f32 v150, v150
    v_exp_f32 v151, v151
    v_exp_f32 v152, v152
    v_exp_f32 v153, v153
    v_mfma_f32_32x32x16_bf16 v[176:191], v[196:199], v[212:215], v[176:191]
    v_exp_f32 v154, v154
    v_exp_f32 v155, v155
    v_exp_f32 v156, v156
    v_exp_f32 v157, v157
    v_exp_f32 v158, v158
    v_exp_f32 v159, v159
    v_cvt_pk_bf16_f32 v216, v144, v145
    v_cvt_pk_bf16_f32 v217, v146, v147
    v_cvt_pk_bf16_f32 v218, v148, v149
    v_cvt_pk_bf16_f32 v219, v150, v151
    v_cvt_pk_bf16_f32 v220, v152, v153
    v_cvt_pk_bf16_f32 v221, v154, v155
    v_cvt_pk_bf16_f32 v222, v156, v157
    v_cvt_pk_bf16_f32 v223, v158, v159
    s_cmp_le_u32 s83, 2
    s_cbranch_scc1 L_t1_204
    v_mfma_f32_32x32x16_bf16 v[144:159], v[44:47], v[28:31], v[224:239]
    s_getreg_b32 s64, hwreg(HW_REG_IB_STS)
    s_and_b32 s64, s64, 0xc0000f
    s_or_b32 s64, s64, s77
    s_cbranch_scc0 L_ht_208
L_htr_209:
    ds_read_b64_tr_b16 v[192:193], v20 offset:0
    ds_read_b64_tr_b16 v[194:195], v20 offset:256
    ds_read_b64_tr_b16 v[196:197], v20 offset:512
    ds_read_b64_tr_b16 v[198:199], v20 offset:768
    v_sub_u32 v20, v20, v21
    v_exp_f32 v128, v128
    v_exp_f32 v129, v129
    v_exp_f32 v130, v130
    v_exp_f32 v131, v131
    v_exp_f32 v132, v132
    s_waitcnt lgkmcnt(4)
    v_mfma_f32_32x32x16_bf16 v[176:191], v[200:203], v[216:219], v[176:191]
    v_exp_f32 v133, v133
    v_exp_f32 v134, v134
    v_exp_f32 v135, v135
    v_exp_f32 v136, v136
    v_exp_f32 v137, v137
    v_mfma_f32_32x32x16_bf16 v[176:191], v[204:207], v[220:223], v[176:191]
    v_exp_f32 v138, v138
    v_exp_f32 v139, v139
    v_exp_f32 v140, v140
    v_exp_f32 v141, v141
    v_exp_f32 v142, v142
    v_exp_f32 v143, v143
    v_cvt_pk_bf16_f32 v208, v128, v129
    v_cvt_pk_bf16_f32 v209, v130, v131
    v_cvt_pk_bf16_f32 v210, v132, v133
    v_cvt_pk_bf16_f32 v211, v134, v135
    v_cvt_pk_bf16_f32 v212, v136, v137
    v_cvt_pk_bf16_f32 v213, v138, v139
    v_cvt_pk_bf16_f32 v214, v140, v141
    v_cvt_pk_bf16_f32 v215, v142, v143
    s_cmp_le_u32 s83, 3
    s_cbranch_scc1 L_t0_203
    v_mfma_f32_32x32x16_bf16 v[128:143], v[48:51], v[28:31], v[224:239]
    s_getreg_b32 s64, hwreg(HW_REG_IB_STS)
    s_and_b32 s64, s64, 0xc0000f
    s_or_b32 s64, s64, s77
    s_cbranch_scc0 L_ht_210
L_htr_211:
    ds_read_b64_tr_b16 v[200:201], v20 offset:0
    ds_read_b64_tr_b16 v[202:203], v20 offset:256
    ds_read_b64_tr_b16 v[204:205], v20 offset:512
    ds_read_b64_tr_b16 v[206:207], v20 offset:768
    v_sub_u32 v20, v20, v21
    v_exp_f32 v144, v144
    v_exp_f32 v145, v145
    v_exp_f32 v146, v146
    v_exp_f32 v147, v147
    v_exp_f32 v148, v148
    s_waitcnt lgkmcnt(4)
    v_mfma_f32_32x32x16_bf16 v[176:191], v[192:195], v[208:211], v[176:191]
    v_exp_f32 v149, v149
    v_exp_f32 v150, v150
    v_exp_f32 v151, v151
    v_exp_f32 v152, v152
    v_exp_f32 v153, v153
    v_mfma_f32_32x32x16_bf16 v[176:191], v[196:199], v[212:215], v[176:191]
    v_exp_f32 v154, v154
    v_exp_f32 v155, v155
    v_exp_f32 v156, v156
    v_exp_f32 v157, v157
    v_exp_f32 v158, v158
    v_exp_f32 v159, v159
    v_cvt_pk_bf16_f32 v216, v144, v145
    v_cvt_pk_bf16_f32 v217, v146, v147
    v_cvt_pk_bf16_f32 v218, v148, v149
    v_cvt_pk_bf16_f32 v219, v150, v151
    v_cvt_pk_bf16_f32 v220, v152, v153
    v_cvt_pk_bf16_f32 v221, v154, v155
    v_cvt_pk_bf16_f32 v222, v156, v157
    v_cvt_pk_bf16_f32 v223, v158, v159
    s_cmp_le_u32 s83, 4
    s_cbranch_scc1 L_t1_204
    v_mfma_f32_32x32x16_bf16 v[144:159], v[52:55], v[28:31], v[224:239]
    s_getreg_b32 s64, hwreg(HW_REG_IB_STS)
    s_and_b32 s64, s64, 0xc0000f
    s_or_b32 s64, s64, s77
    s_cbranch_scc0 L_ht_212
L_htr_213:
    ds_read_b64_tr_b16 v[192:193], v20 offset:0
    ds_read_b64_tr_b16 v[194:195], v20 offset:256
    ds_read_b64_tr_b16 v[196:197], v20 offset:512
    ds_read_b64_tr_b16 v[198:199], v20 offset:768
    v_sub_u32 v20, v20, v21
    v_exp_f32 v128, v128
    v_exp_f32 v129, v129
    v_exp_f32 v130, v130
    v_exp_f32 v131, v131
    v_exp_f32 v132, v132
    s_waitcnt lgkmcnt(4)
    v_mfma_f32_32x32x16_bf16 v[176:191], v[200:203], v[216:219], v[176:191]
    v_exp_f32 v133, v133
    v_exp_f32 v134, v134
    v_exp_f32 v135, v135
    v_exp_f32 v136, v136
    v_exp_f32 v137, v137
    v_mfma_f32_32x32x16_bf16 v[176:191], v[204:207], v[220:223], v[176:191]
    v_exp_f32 v138, v138
    v_exp_f32 v139, v139
    v_exp_f32 v140, v140
    v_exp_f32 v141, v141
    v_exp_f32 v142, v142
    v_exp_f32 v143, v143
    v_cvt_pk_bf16_f32 v208, v128, v129
    v_cvt_pk_bf16_f32 v209, v130, v131
    v_cvt_pk_bf16_f32 v210, v132, v133
    v_cvt_pk_bf16_f32 v211, v134, v135
    v_cvt_pk_bf16_f32 v212, v136, v137
    v_cvt_pk_bf16_f32 v213, v138, v139
    v_cvt_pk_bf16_f32 v214, v140, v141
    v_cvt_pk_bf16_f32 v215, v142, v143
    s_cmp_le_u32 s83, 5
    s_cbranch_scc1 L_t0_203
    v_mfma_f32_32x32x16_bf16 v[128:143], v[56:59], v[28:31], v[224:239]
    ds_read_b64_tr_b16 v[200:201], v20 offset:0
    ds_read_b64_tr_b16 v[202:203], v20 offset:256
    ds_read_b64_tr_b16 v[204:205], v20 offset:512
    ds_read_b64_tr_b16 v[206:207], v20 offset:768
    v_sub_u32 v20, v20, v21
    v_exp_f32 v144, v144
    v_exp_f32 v145, v145
    v_exp_f32 v146, v146
    v_exp_f32 v147, v147
    v_exp_f32 v148, v148
    s_waitcnt lgkmcnt(4)
    v_mfma_f32_32x32x16_bf16 v[176:191], v[192:195], v[208:211], v[176:191]
    v_exp_f32 v149, v149
    v_exp_f32 v150, v150
    v_exp_f32 v151, v151
    v_exp_f32 v152, v152
    v_exp_f32 v153, v153
    v_mfma_f32_32x32x16_bf16 v[176:191], v[196:199], v[212:215], v[176:191]
    v_exp_f32 v154, v154
    v_exp_f32 v155, v155
    v_exp_f32 v156, v156
    v_exp_f32 v157, v157
    v_exp_f32 v158, v158
    v_exp_f32 v159, v159
    v_cvt_pk_bf16_f32 v216, v144, v145
    v_cvt_pk_bf16_f32 v217, v146, v147
    v_cvt_pk_bf16_f32 v218, v148, v149
    v_cvt_pk_bf16_f32 v219, v150, v151
    v_cvt_pk_bf16_f32 v220, v152, v153
    v_cvt_pk_bf16_f32 v221, v154, v155
    v_cvt_pk_bf16_f32 v222, v156, v157
    v_cvt_pk_bf16_f32 v223, v158, v159
    s_cmp_le_u32 s83, 6
    s_cbranch_scc1 L_t1_204
    v_mfma_f32_32x32x16_bf16 v[144:159], v[60:63], v[28:31], v[224:239]
    s_getreg_b32 s64, hwreg(HW_REG_IB_STS)
    s_and_b32 s64, s64, 0xc0000f
    s_or_b32 s64, s64, s77
    s_cbranch_scc0 L_ht_214
L_htr_215:
    ds_read_b64_tr_b16 v[192:193], v20 offset:0
    ds_read_b64_tr_b16 v[194:195], v20 offset:256
    ds_read_b64_tr_b16 v[196:197], v20 offset:512
    ds_read_b64_tr_b16 v[198:199], v20 offset:768
    v_sub_u32 v20, v20, v21
    v_exp_f32 v128, v128
    v_exp_f32 v129, v129
    v_exp_f32 v130, v130
    v_exp_f32 v131, v131
    v_exp_f32 v132, v132
    s_waitcnt lgkmcnt(4)
    v_mfma_f32_32x32x16_bf16 v[176:191], v[200:203], v[216:219], v[176:191]
    v_exp_f32 v133, v133
    v_exp_f32 v134, v134
    v_exp_f32 v135, v135
    v_exp_f32 v136, v136
    v_exp_f32 v137, v137
    v_mfma_f32_32x32x16_bf16 v[176:191], v[204:207], v[220:223], v[176:191]
    v_exp_f32 v138, v138
    v_exp_f32 v139, v139
    v_exp_f32 v140, v140
    v_exp_f32 v141, v141
    v_exp_f32 v142, v142
    v_exp_f32 v143, v143
    v_cvt_pk_bf16_f32 v208, v128, v129
    v_cvt_pk_bf16_f32 v209, v130, v131
    v_cvt_pk_bf16_f32 v210, v132, v133
    v_cvt_pk_bf16_f32 v211, v134, v135
    v_cvt_pk_bf16_f32 v212, v136, v137
    v_cvt_pk_bf16_f32 v213, v138, v139
    v_cvt_pk_bf16_f32 v214, v140, v141
    v_cvt_pk_bf16_f32 v215, v142, v143
    s_cmp_le_u32 s83, 7
    s_cbranch_scc1 L_t0_203
    v_mfma_f32_32x32x16_bf16 v[128:143], v[64:67], v[28:31], v[224:239]
    ds_read_b64_tr_b16 v[200:201], v20 offset:0
    ds_read_b64_tr_b16 v[202:203], v20 offset:256
    ds_read_b64_tr_b16 v[204:205], v20 offset:512
    ds_read_b64_tr_b16 v[206:207], v20 offset:768
    v_sub_u32 v20, v20, v21
    v_exp_f32 v144, v144
    v_exp_f32 v145, v145
    v_exp_f32 v146, v146
    v_exp_f32 v147, v147
    v_exp_f32 v148, v148
    s_waitcnt lgkmcnt(4)
    v_mfma_f32_32x32x16_bf16 v[176:191], v[192:195], v[208:211], v[176:191]
    v_exp_f32 v149, v149
    v_exp_f32 v150, v150
    v_exp_f32 v151, v151
    v_exp_f32 v152, v152
    v_exp_f32 v153, v153
    v_mfma_f32_32x32x16_bf16 v[176:191], v[196:199], v[212:215], v[176:191]
    v_exp_f32 v154, v154
    v_exp_f32 v155, v155
    v_exp_f32 v156, v156
    v_exp_f32 v157, v157
    v_exp_f32 v158, v158
    v_exp_f32 v159, v159
    v_cvt_pk_bf16_f32 v216, v144, v145
    v_cvt_pk_bf16_f32 v217, v146, v147
    v_cvt_pk_bf16_f32 v218, v148, v149
    v_cvt_pk_bf16_f32 v219, v150, v151
    v_cvt_pk_bf16_f32 v220, v152, v153
    v_cvt_pk_bf16_f32 v221, v154, v155
    v_cvt_pk_bf16_f32 v222, v156, v157
    v_cvt_pk_bf16_f32 v223, v158, v159
    s_cmp_le_u32 s83, 8
    s_cbranch_scc1 L_t1_204
    s_getreg_b32 s64, hwreg(HW_REG_IB_STS)
    s_and_b32 s64, s64, 0xc0000f
    s_or_b32 s64, s64, s77
    s_cbranch_scc0 L_ht_216
L_htr_217:
    ds_read_b64_tr_b16 v[192:193], v20 offset:0
    ds_read_b64_tr_b16 v[194:195], v20 offset:256
    ds_read_b64_tr_b16 v[196:197], v20 offset:512
    ds_read_b64_tr_b16 v[198:199], v20 offset:768
    v_sub_u32 v20, v20, v21
    v_exp_f32 v128, v128
    v_exp_f32 v129, v129
    v_exp_f32 v130, v130
    v_exp_f32 v131, v131
    v_exp_f32 v132, v132
    s_waitcnt lgkmcnt(4)
    v_mfma_f32_32x32x16_bf16 v[176:191], v[200:203], v[216:219], v[176:191]
    v_exp_f32 v133, v133
    v_exp_f32 v134, v134
    v_exp_f32 v135, v135
    v_exp_f32 v136, v136
    v_exp_f32 v137, v137
    v_mfma_f32_32x32x16_bf16 v[176:191], v[204:207], v[220:223], v[176:191]
    v_exp_f32 v138, v138
    v_exp_f32 v139, v139
    v_exp_f32 v140, v140
    v_exp_f32 v141, v141
    v_exp_f32 v142, v142
    v_exp_f32 v143, v143
    v_cvt_pk_bf16_f32 v208, v128, v129
    v_cvt_pk_bf16_f32 v209, v130, v131
    v_cvt_pk_bf16_f32 v210, v132, v133
    v_cvt_pk_bf16_f32 v211, v134, v135
    v_cvt_pk_bf16_f32 v212, v136, v137
    v_cvt_pk_bf16_f32 v213, v138, v139
    v_cvt_pk_bf16_f32 v214, v140, v141
    v_cvt_pk_bf16_f32 v215, v142, v143
    v_bfi_b32 v208, v104, 0, v208
    v_bfi_b32 v209, v105, 0, v209
    v_bfi_b32 v210, v106, 0, v210
    v_bfi_b32 v211, v107, 0, v211
    v_bfi_b32 v212, v108, 0, v212
    v_bfi_b32 v213, v109, 0, v213
    v_bfi_b32 v214, v110, 0, v214
    v_bfi_b32 v215, v111, 0, v215
L_t0_203:
    s_waitcnt lgkmcnt(0)
    s_nop 1
    v_mfma_f32_32x32x16_bf16 v[176:191], v[192:195], v[208:211], v[176:191]
    v_mfma_f32_32x32x16_bf16 v[176:191], v[196:199], v[212:215], v[176:191]
    s_branch L_fin_205
L_t1_204:
    s_waitcnt lgkmcnt(0)
    s_nop 1
    v_mfma_f32_32x32x16_bf16 v[176:191], v[200:203], v[216:219], v[176:191]
    v_mfma_f32_32x32x16_bf16 v[176:191], v[204:207], v[220:223], v[176:191]
L_fin_205:
    s_nop 11
    v_rcp_f32 v17, v184
    s_nop 0
    v_mul_f32 v176, v176, v17
    v_mul_f32 v177, v177, v17
    v_mul_f32 v178, v178, v17
    v_mul_f32 v179, v179, v17
    v_mul_f32 v180, v180, v17
    v_mul_f32 v181, v181, v17
    v_mul_f32 v182, v182, v17
    v_mul_f32 v183, v183, v17
    v_cvt_pk_bf16_f32 v244, v176, v177
    v_cvt_pk_bf16_f32 v245, v178, v179
    v_cvt_pk_bf16_f32 v246, v180, v181
    v_cvt_pk_bf16_f32 v247, v182, v183
    s_add_u32 s64, s96, 147456
    s_mov_b32 s77, 0
    buffer_store_dwordx4 v[244:247], v10, s[48:51], s64 offen sc1
    s_waitcnt vmcnt(0)
    v_mov_b32 v18, s80
    v_mov_b32 v19, s81
    s_mov_b64 exec, 1
    buffer_store_dwordx2 v[18:19], v7, s[48:51], s97 offen sc1
    s_mov_b64 exec, -1
    s_add_u32 s97, s97, 4096
    v_mov_b32 v18, s80
    v_mov_b32 v19, s81
    s_mov_b64 exec, 1
    buffer_store_dwordx2 v[18:19], v7, s[48:51], s97 offen sc1
    s_mov_b64 exec, -1
    s_mov_b32 s82, 0
L_kr_218:
    ds_read_b32 v18, v14 offset:4
    s_add_u32 s82, s82, 1
    s_waitcnt lgkmcnt(0)
    v_readfirstlane_b32 s64, v18
    s_nop 0
    s_cmp_ge_u32 s64, 4
    s_cbranch_scc1 L_krd_219
    s_cmp_gt_u32 s82, 480000
    s_cbranch_scc1 L_krd_219
    s_sleep 2
    s_branch L_kr_218
L_krd_219:
    v_lshrrev_b32 v18, 3, v0
    v_xor_b32 v19, v18, v0
    v_and_b32 v19, 7, v19
    v_lshlrev_b32 v19, 4, v19
    v_lshl_add_u32 v18, v18, 7, v19
    s_lshl_b32 s64, s62, 11
    s_add_u32 s64, s64, 131072
    v_add_u32 v18, s64, v18
    ds_write_b128 v18, v[248:251]
    ds_write_b128 v18, v[252:255] offset:1024
    s_waitcnt lgkmcnt(0)
    s_barrier
    s_endpgm
L_ht_189:
    s_waitcnt vmcnt(0)
    s_mov_b64 exec, 1
    ds_add_u32 v14, v15 offset:8
    s_mov_b64 exec, -1
    s_mov_b32 s77, 1
    s_branch L_htr_190
L_ht_191:
    s_waitcnt vmcnt(0)
    s_mov_b64 exec, 1
    ds_add_u32 v14, v15 offset:8
    s_mov_b64 exec, -1
    s_mov_b32 s77, 1
    s_branch L_htr_192
L_ht_193:
    s_waitcnt vmcnt(0)
    s_mov_b64 exec, 1
    ds_add_u32 v14, v15 offset:8
    s_mov_b64 exec, -1
    s_mov_b32 s77, 1
    s_branch L_htr_194
L_ht_195:
    s_waitcnt vmcnt(0)
    s_mov_b64 exec, 1
    ds_add_u32 v14, v15 offset:8
    s_mov_b64 exec, -1
    s_mov_b32 s77, 1
    s_branch L_htr_196
L_ht_197:
    s_waitcnt vmcnt(0)
    s_mov_b64 exec, 1
    ds_add_u32 v14, v15 offset:8
    s_mov_b64 exec, -1
    s_mov_b32 s77, 1
    s_branch L_htr_198
L_ht_199:
    s_waitcnt vmcnt(0)
    s_mov_b64 exec, 1
    ds_add_u32 v14, v15 offset:8
    s_mov_b64 exec, -1
    s_mov_b32 s77, 1
    s_branch L_htr_200
L_ht_201:
    s_waitcnt vmcnt(0)
    s_mov_b64 exec, 1
    ds_add_u32 v14, v15 offset:8
    s_mov_b64 exec, -1
    s_mov_b32 s77, 1
    s_branch L_htr_202
L_ht_206:
    s_waitcnt vmcnt(0)
    v_mov_b32 v18, s80
    v_mov_b32 v19, s81
    s_mov_b64 exec, 1
    buffer_store_dwordx2 v[18:19], v7, s[48:51], s97 offen sc1
    s_mov_b64 exec, -1
    s_mov_b32 s77, 1
    s_branch L_htr_207
L_ht_208:
    s_waitcnt vmcnt(0)
    v_mov_b32 v18, s80
    v_mov_b32 v19, s81
    s_mov_b64 exec, 1
    buffer_store_dwordx2 v[18:19], v7, s[48:51], s97 offen sc1
    s_mov_b64 exec, -1
    s_mov_b32 s77, 1
    s_branch L_htr_209
L_ht_210:
    s_waitcnt vmcnt(0)
    v_mov_b32 v18, s80
    v_mov_b32 v19, s81
    s_mov_b64 exec, 1
    buffer_store_dwordx2 v[18:19], v7, s[48:51], s97 offen sc1
    s_mov_b64 exec, -1
    s_mov_b32 s77, 1
    s_branch L_htr_211
L_ht_212:
    s_waitcnt vmcnt(0)
    v_mov_b32 v18, s80
    v_mov_b32 v19, s81
    s_mov_b64 exec, 1
    buffer_store_dwordx2 v[18:19], v7, s[48:51], s97 offen sc1
    s_mov_b64 exec, -1
    s_mov_b32 s77, 1
    s_branch L_htr_213
L_ht_214:
    s_waitcnt vmcnt(0)
    v_mov_b32 v18, s80
    v_mov_b32 v19, s81
    s_mov_b64 exec, 1
    buffer_store_dwordx2 v[18:19], v7, s[48:51], s97 offen sc1
    s_mov_b64 exec, -1
    s_mov_b32 s77, 1
    s_branch L_htr_215
L_ht_216:
    s_waitcnt vmcnt(0)
    v_mov_b32 v18, s80
    v_mov_b32 v19, s81
    s_mov_b64 exec, 1
    buffer_store_dwordx2 v[18:19], v7, s[48:51], s97 offen sc1
    s_mov_b64 exec, -1
    s_mov_b32 s77, 1
    s_branch L_htr_217
L_M:
    s_cmp_lg_u32 s62, 3
    s_cbranch_scc1 L_code_220
    s_getpc_b64 s[66:67]
L_PC:
    s_sub_u32 s66, s66, L_PC-parallel_sum__sliding_block__dense_activation_relu__prompt_kernel
    s_subb_u32 s67, s67, 0
    s_lshr_b32 s65, s2, 3
    s_mul_i32 s65, s65, 1152
    v_lshlrev_b32 v18, 7, v0
    v_add_u32 v18, s65, v18
    s_mov_b64 exec, 511
    global_load_dword v210, v18, s[66:67]
    s_mov_b64 exec, -1
L_code_220:
    v_mov_b32 v15, 0
    s_or_b32 s64, s2, s56
    s_cmp_lg_u32 s64, 0
    s_cbranch_scc1 L_non_221
    s_memrealtime s[80:81]
    s_waitcnt lgkmcnt(0)
    s_mov_b32 s52, s18
    s_and_b32 s53, s19, 0xffff
    s_mov_b32 s54, 256
    s_mov_b32 s55, 0x20000
    s_or_b32 s80, s80, 1
    s_xor_b32 s81, s81, 0x5a3c96e1
    v_mov_b32 v18, s80
    v_mov_b32 v19, s81
    s_mov_b64 exec, 1
    buffer_store_dwordx2 v[18:19], v15, s[52:55], 0 offen sc1
    s_mov_b64 exec, -1
    s_nop 1
L_non_221:
    s_and_b32 s64, s58, 3
    s_lshl_b32 s64, s64, 2
    s_mul_i32 s65, s59, 448
    s_lshr_b32 s74, 0x3140, s64
    s_and_b32 s74, s74, 15
    s_lshl_b32 s74, s74, 6
    s_add_u32 s74, s74, s65
    s_lshr_b32 s75, 0x6073, s64
    s_and_b32 s75, s75, 15
    s_lshl_b32 s75, s75, 6
    s_add_u32 s75, s75, s65
    s_sub_u32 s75, s75, 64
    s_and_b32 s64, s2, 7
    s_lshr_b32 s65, s2, 3
    s_lshl_b32 s60, s64, 2
    s_and_b32 s66, s65, 3
    s_add_u32 s60, s60, s66
    s_lshr_b32 s61, s65, 2
    v_and_b32 v18, 31, v0
    s_lshl_b32 s64, s62, 5
    v_add_u32 v18, s64, v18
    v_lshlrev_b32 v18, 7, v18
    v_lshrrev_b32 v19, 5, v0
    v_bfe_u32 v2, v0, 1, 3
    v_xor_b32 v19, v19, v2
    v_lshl_add_u32 v2, v19, 4, v18
    v_xor_b32 v3, 32, v2
    v_xor_b32 v4, 64, v2
    v_xor_b32 v5, 96, v2
    v_lshrrev_b32 v6, 5, v0
    v_lshlrev_b32 v6, 10, v6
    v_bfe_u32 v18, v0, 2, 2
    v_lshl_add_u32 v6, v18, 7, v6
    v_bfe_u32 v18, v0, 3, 1
    v_lshl_add_u32 v6, v18, 6, v6
    v_bfe_u32 v18, v0, 4, 1
    v_lshl_add_u32 v6, v18, 5, v6
    v_bfe_u32 v18, v0, 0, 1
    v_lshl_add_u32 v6, v18, 4, v6
    v_bfe_u32 v18, v0, 1, 1
    v_lshl_add_u32 v6, v18, 3, v6
    v_xor_b32 v7, 64, v6
    v_add_u32 v8, 65536, v6
    v_add_u32 v9, 65536, v7
    v_and_b32 v10, 63, v6
    v_lshrrev_b32 v18, 7, v6
    v_lshl_add_u32 v10, v18, 6, v10
    v_add_u32 v10, 65536, v10
    v_and_b32 v11, 0x13, v0
    v_bfe_u32 v18, v0, 2, 1
    v_lshl_add_u32 v11, v18, 3, v11
    v_bfe_u32 v18, v0, 3, 1
    v_lshl_add_u32 v11, v18, 2, v11
    v_lshlrev_b32 v11, 2, v11
    v_add_u32 v11, 156672, v11
    v_lshlrev_b32 v13, 4, v0
    v_and_b32 v14, 31, v0
    v_lshlrev_b32 v14, 5, v14
    v_lshrrev_b32 v18, 5, v0
    v_lshl_add_u32 v14, v18, 4, v14
    v_mov_b32 v20, 0
    v_mov_b32 v21, 0
    v_mov_b32 v22, 0
    v_mov_b32 v23, 0
    v_mov_b32 v96, 0
    v_mov_b32 v97, 0
    v_mov_b32 v98, 0
    v_mov_b32 v99, 0
    v_mov_b32 v100, 0
    v_mov_b32 v101, 0
    v_mov_b32 v102, 0
    v_mov_b32 v103, 0
    v_mov_b32 v104, 0
    v_mov_b32 v105, 0
    v_mov_b32 v106, 0
    v_mov_b32 v107, 0
    s_cmp_lg_u32 s56, 0
    s_cbranch_scc1 L_init_222
    v_mov_b32 v24, 0x3f803f80
    v_mov_b32 v25, 0x3f803f80
    v_mov_b32 v26, 0x3f803f80
    v_mov_b32 v27, 0x3f803f80
    v_add_u32 v18, 157696, v13
    ds_write_b128 v18, v[24:27]
    v_mov_b32 v18, 158720
    ds_write_b128 v18, v[20:23]
    ds_write_b128 v18, v[20:23] offset:16
L_init_222:
    s_waitcnt lgkmcnt(0)
    s_mov_b32 s48, s20
    s_and_b32 s49, s21, 0xffff
    s_mov_b32 s50, 17235968
    s_mov_b32 s51, 0x20000
    s_mov_b32 s52, s18
    s_and_b32 s53, s19, 0xffff
    s_mov_b32 s54, 256
    s_mov_b32 s55, 0x20000
    s_mov_b32 s36, s14
    s_and_b32 s37, s15, 0xffff
    s_mov_b32 s38, 1835008
    s_mov_b32 s39, 0x20000
    s_mov_b32 s40, s8
    s_and_b32 s41, s9, 0xffff
    s_mov_b32 s42, 524288
    s_mov_b32 s43, 0x20000
    s_mov_b32 s44, s16
    s_and_b32 s45, s17, 0xffff
    s_mov_b32 s46, 2097152
    s_mov_b32 s47, 0x20000
    s_lshl_b32 s64, s57, 2
    s_add_u32 s64, s64, s62
    s_lshl_b32 s66, s64, 10
    s_lshl_b32 s69, s58, 17
    s_add_u32 s69, s69, s66
    s_add_u32 s68, s69, 11534336
    s_add_u32 s69, s69, 13631488
    s_lshl_b32 s72, s64, 5
    s_add_u32 s72, s72, s58
    s_lshl_b32 s72, s72, 7
    s_add_u32 s72, s72, 15728640
    s_mul_i32 s67, s64, 147456
    s_lshl_b32 s70, s74, 5
    s_add_u32 s70, s70, s67
    s_lshl_b32 s71, s75, 5
    s_add_u32 s71, s71, s67
    s_and_b32 s64, s58, 3
    s_cmp_eq_u32 s64, 2
    s_cselect_b32 s76, 64, 0
    s_lshl_b32 s64, s76, 5
    s_add_u32 s71, s71, s64
    s_barrier
    ds_read_b128 v[128:131], v2 offset:0
    ds_read_b64_tr_b16 v[24:25], v10 offset:0
    ds_read_b64_tr_b16 v[26:27], v10 offset:256
    ds_read_b64_tr_b16 v[28:29], v10 offset:4096
    ds_read_b64_tr_b16 v[30:31], v10 offset:4352
    ds_read_b64_tr_b16 v[32:33], v10 offset:8192
    ds_read_b64_tr_b16 v[34:35], v10 offset:8448
    ds_read_b128 v[132:135], v3 offset:0
    ds_read_b64_tr_b16 v[36:37], v10 offset:1024
    ds_read_b64_tr_b16 v[38:39], v10 offset:1280
    ds_read_b64_tr_b16 v[40:41], v10 offset:5120
    ds_read_b64_tr_b16 v[42:43], v10 offset:5376
    ds_read_b64_tr_b16 v[44:45], v10 offset:9216
    ds_read_b64_tr_b16 v[46:47], v10 offset:9472
    s_waitcnt lgkmcnt(7)
    v_mfma_f32_32x32x16_bf16 v[48:63], v[24:27], v[128:131], 0
    ds_read_b128 v[136:139], v4 offset:0
    ds_read_b64_tr_b16 v[112:113], v10 offset:2048
    ds_read_b64_tr_b16 v[114:115], v10 offset:2304
    v_mfma_f32_32x32x16_bf16 v[64:79], v[28:31], v[128:131], 0
    ds_read_b64_tr_b16 v[116:117], v10 offset:6144
    ds_read_b64_tr_b16 v[118:119], v10 offset:6400
    ds_read_b64_tr_b16 v[120:121], v10 offset:10240
    v_mfma_f32_32x32x16_bf16 v[80:95], v[32:35], v[128:131], 0
    ds_read_b64_tr_b16 v[122:123], v10 offset:10496
    s_waitcnt lgkmcnt(7)
    v_mfma_f32_32x32x16_bf16 v[48:63], v[36:39], v[132:135], v[48:63]
    ds_read_b128 v[140:143], v5 offset:0
    ds_read_b64_tr_b16 v[24:25], v10 offset:3072
    ds_read_b64_tr_b16 v[26:27], v10 offset:3328
    v_mfma_f32_32x32x16_bf16 v[64:79], v[40:43], v[132:135], v[64:79]
    ds_read_b64_tr_b16 v[28:29], v10 offset:7168
    ds_read_b64_tr_b16 v[30:31], v10 offset:7424
    ds_read_b64_tr_b16 v[32:33], v10 offset:11264
    v_mfma_f32_32x32x16_bf16 v[80:95], v[44:47], v[132:135], v[80:95]
    ds_read_b64_tr_b16 v[34:35], v10 offset:11520
    s_waitcnt lgkmcnt(0)
    s_barrier
    v_mfma_f32_32x32x16_bf16 v[48:63], v[112:115], v[136:139], v[48:63]
    ds_read_b128 v[144:147], v2 offset:16384
    ds_read_b64_tr_b16 v[36:37], v10 offset:16384
    ds_read_b64_tr_b16 v[38:39], v10 offset:16640
    v_mfma_f32_32x32x16_bf16 v[64:79], v[116:119], v[136:139], v[64:79]
    ds_read_b64_tr_b16 v[40:41], v10 offset:20480
    ds_read_b64_tr_b16 v[42:43], v10 offset:20736
    ds_read_b64_tr_b16 v[44:45], v10 offset:24576
    v_mfma_f32_32x32x16_bf16 v[80:95], v[120:123], v[136:139], v[80:95]
    ds_read_b64_tr_b16 v[46:47], v10 offset:24832
    s_waitcnt lgkmcnt(7)
    v_mfma_f32_32x32x16_bf16 v[48:63], v[24:27], v[140:143], v[48:63]
    ds_read_b128 v[148:151], v3 offset:16384
    ds_read_b64_tr_b16 v[112:113], v10 offset:17408
    ds_read_b64_tr_b16 v[114:115], v10 offset:17664
    v_mfma_f32_32x32x16_bf16 v[64:79], v[28:31], v[140:143], v[64:79]
    ds_read_b64_tr_b16 v[116:117], v10 offset:21504
    ds_read_b64_tr_b16 v[118:119], v10 offset:21760
    ds_read_b64_tr_b16 v[120:121], v10 offset:25600
    v_mfma_f32_32x32x16_bf16 v[80:95], v[32:35], v[140:143], v[80:95]
    ds_read_b64_tr_b16 v[122:123], v10 offset:25856
    s_waitcnt lgkmcnt(7)
    v_mfma_f32_32x32x16_bf16 v[48:63], v[36:39], v[144:147], v[48:63]
    ds_read_b128 v[152:155], v4 offset:16384
    ds_read_b64_tr_b16 v[24:25], v10 offset:18432
    ds_read_b64_tr_b16 v[26:27], v10 offset:18688
    v_mfma_f32_32x32x16_bf16 v[64:79], v[40:43], v[144:147], v[64:79]
    ds_read_b64_tr_b16 v[28:29], v10 offset:22528
    ds_read_b64_tr_b16 v[30:31], v10 offset:22784
    ds_read_b64_tr_b16 v[32:33], v10 offset:26624
    v_mfma_f32_32x32x16_bf16 v[80:95], v[44:47], v[144:147], v[80:95]
    ds_read_b64_tr_b16 v[34:35], v10 offset:26880
    s_waitcnt lgkmcnt(7)
    v_mfma_f32_32x32x16_bf16 v[48:63], v[112:115], v[148:151], v[48:63]
    ds_read_b128 v[156:159], v5 offset:16384
    ds_read_b64_tr_b16 v[36:37], v10 offset:19456
    ds_read_b64_tr_b16 v[38:39], v10 offset:19712
    v_mfma_f32_32x32x16_bf16 v[64:79], v[116:119], v[148:151], v[64:79]
    ds_read_b64_tr_b16 v[40:41], v10 offset:23552
    ds_read_b64_tr_b16 v[42:43], v10 offset:23808
    ds_read_b64_tr_b16 v[44:45], v10 offset:27648
    v_mfma_f32_32x32x16_bf16 v[80:95], v[120:123], v[148:151], v[80:95]
    ds_read_b64_tr_b16 v[46:47], v10 offset:27904
    buffer_load_dwordx2 v[208:209], v15, s[52:55], 0 offen sc1
    s_waitcnt lgkmcnt(0)
    s_barrier
    v_mfma_f32_32x32x16_bf16 v[48:63], v[24:27], v[152:155], v[48:63]
    ds_read_b128 v[160:163], v2 offset:32768
    ds_read_b64_tr_b16 v[112:113], v10 offset:32768
    ds_read_b64_tr_b16 v[114:115], v10 offset:33024
    v_mfma_f32_32x32x16_bf16 v[64:79], v[28:31], v[152:155], v[64:79]
    ds_read_b64_tr_b16 v[116:117], v10 offset:36864
    ds_read_b64_tr_b16 v[118:119], v10 offset:37120
    ds_read_b64_tr_b16 v[120:121], v10 offset:40960
    v_mfma_f32_32x32x16_bf16 v[80:95], v[32:35], v[152:155], v[80:95]
    ds_read_b64_tr_b16 v[122:123], v10 offset:41216
    s_waitcnt lgkmcnt(7)
    v_mfma_f32_32x32x16_bf16 v[48:63], v[36:39], v[156:159], v[48:63]
    ds_read_b128 v[164:167], v3 offset:32768
    ds_read_b64_tr_b16 v[24:25], v10 offset:33792
    ds_read_b64_tr_b16 v[26:27], v10 offset:34048
    v_mfma_f32_32x32x16_bf16 v[64:79], v[40:43], v[156:159], v[64:79]
    ds_read_b64_tr_b16 v[28:29], v10 offset:37888
    ds_read_b64_tr_b16 v[30:31], v10 offset:38144
    ds_read_b64_tr_b16 v[32:33], v10 offset:41984
    v_mfma_f32_32x32x16_bf16 v[80:95], v[44:47], v[156:159], v[80:95]
    ds_read_b64_tr_b16 v[34:35], v10 offset:42240
    s_waitcnt lgkmcnt(7)
    v_mfma_f32_32x32x16_bf16 v[48:63], v[112:115], v[160:163], v[48:63]
    ds_read_b128 v[168:171], v4 offset:32768
    ds_read_b64_tr_b16 v[36:37], v10 offset:34816
    ds_read_b64_tr_b16 v[38:39], v10 offset:35072
    v_mfma_f32_32x32x16_bf16 v[64:79], v[116:119], v[160:163], v[64:79]
    ds_read_b64_tr_b16 v[40:41], v10 offset:38912
    ds_read_b64_tr_b16 v[42:43], v10 offset:39168
    ds_read_b64_tr_b16 v[44:45], v10 offset:43008
    v_mfma_f32_32x32x16_bf16 v[80:95], v[120:123], v[160:163], v[80:95]
    ds_read_b64_tr_b16 v[46:47], v10 offset:43264
    s_waitcnt lgkmcnt(7)
    v_mfma_f32_32x32x16_bf16 v[48:63], v[24:27], v[164:167], v[48:63]
    ds_read_b128 v[172:175], v5 offset:32768
    ds_read_b64_tr_b16 v[112:113], v10 offset:35840
    ds_read_b64_tr_b16 v[114:115], v10 offset:36096
    v_mfma_f32_32x32x16_bf16 v[64:79], v[28:31], v[164:167], v[64:79]
    ds_read_b64_tr_b16 v[116:117], v10 offset:39936
    ds_read_b64_tr_b16 v[118:119], v10 offset:40192
    ds_read_b64_tr_b16 v[120:121], v10 offset:44032
    v_mfma_f32_32x32x16_bf16 v[80:95], v[32:35], v[164:167], v[80:95]
    ds_read_b64_tr_b16 v[122:123], v10 offset:44288
    s_waitcnt lgkmcnt(0)
    s_barrier
    v_mfma_f32_32x32x16_bf16 v[48:63], v[36:39], v[168:171], v[48:63]
    ds_read_b128 v[176:179], v2 offset:49152
    ds_read_b64_tr_b16 v[24:25], v10 offset:49152
    ds_read_b64_tr_b16 v[26:27], v10 offset:49408
    v_mfma_f32_32x32x16_bf16 v[64:79], v[40:43], v[168:171], v[64:79]
    ds_read_b64_tr_b16 v[28:29], v10 offset:53248
    ds_read_b64_tr_b16 v[30:31], v10 offset:53504
    ds_read_b64_tr_b16 v[32:33], v10 offset:57344
    v_mfma_f32_32x32x16_bf16 v[80:95], v[44:47], v[168:171], v[80:95]
    ds_read_b64_tr_b16 v[34:35], v10 offset:57600
    s_waitcnt lgkmcnt(7)
    v_mfma_f32_32x32x16_bf16 v[48:63], v[112:115], v[172:175], v[48:63]
    ds_read_b128 v[180:183], v3 offset:49152
    ds_read_b64_tr_b16 v[36:37], v10 offset:50176
    ds_read_b64_tr_b16 v[38:39], v10 offset:50432
    v_mfma_f32_32x32x16_bf16 v[64:79], v[116:119], v[172:175], v[64:79]
    ds_read_b64_tr_b16 v[40:41], v10 offset:54272
    ds_read_b64_tr_b16 v[42:43], v10 offset:54528
    ds_read_b64_tr_b16 v[44:45], v10 offset:58368
    v_mfma_f32_32x32x16_bf16 v[80:95], v[120:123], v[172:175], v[80:95]
    ds_read_b64_tr_b16 v[46:47], v10 offset:58624
    s_waitcnt lgkmcnt(7)
    v_mfma_f32_32x32x16_bf16 v[48:63], v[24:27], v[176:179], v[48:63]
    ds_read_b128 v[184:187], v4 offset:49152
    ds_read_b64_tr_b16 v[112:113], v10 offset:51200
    ds_read_b64_tr_b16 v[114:115], v10 offset:51456
    v_mfma_f32_32x32x16_bf16 v[64:79], v[28:31], v[176:179], v[64:79]
    ds_read_b64_tr_b16 v[116:117], v10 offset:55296
    ds_read_b64_tr_b16 v[118:119], v10 offset:55552
    ds_read_b64_tr_b16 v[120:121], v10 offset:59392
    v_mfma_f32_32x32x16_bf16 v[80:95], v[32:35], v[176:179], v[80:95]
    ds_read_b64_tr_b16 v[122:123], v10 offset:59648
    s_waitcnt lgkmcnt(7)
    v_mfma_f32_32x32x16_bf16 v[48:63], v[36:39], v[180:183], v[48:63]
    ds_read_b128 v[188:191], v5 offset:49152
    ds_read_b64_tr_b16 v[24:25], v10 offset:52224
    ds_read_b64_tr_b16 v[26:27], v10 offset:52480
    v_mfma_f32_32x32x16_bf16 v[64:79], v[40:43], v[180:183], v[64:79]
    ds_read_b64_tr_b16 v[28:29], v10 offset:56320
    ds_read_b64_tr_b16 v[30:31], v10 offset:56576
    ds_read_b64_tr_b16 v[32:33], v10 offset:60416
    v_mfma_f32_32x32x16_bf16 v[80:95], v[44:47], v[180:183], v[80:95]
    ds_read_b64_tr_b16 v[34:35], v10 offset:60672
    s_waitcnt vmcnt(0)
    s_mov_b32 s82, 0
L_non_p_223:
    v_readfirstlane_b32 s80, v208
    v_readfirstlane_b32 s81, v209
    s_cmp_lg_u32 s80, 0
    s_cbranch_scc1 L_non_d_224
    s_add_u32 s82, s82, 1
    s_cmp_gt_u32 s82, 60000
    s_cbranch_scc1 L_non_d_224
    buffer_load_dwordx2 v[208:209], v15, s[52:55], 0 offen sc1
    s_waitcnt vmcnt(0)
    s_branch L_non_p_223
L_non_d_224:
    s_waitcnt lgkmcnt(0)
    s_barrier
    v_mfma_f32_32x32x16_bf16 v[48:63], v[112:115], v[184:187], v[48:63]
    ds_read_b128 v[192:195], v2 offset:0
    ds_read_b64_tr_b16 v[36:37], v10 offset:0
    ds_read_b64_tr_b16 v[38:39], v10 offset:256
    v_mfma_f32_32x32x16_bf16 v[64:79], v[116:119], v[184:187], v[64:79]
    ds_read_b64_tr_b16 v[40:41], v10 offset:4096
    ds_read_b64_tr_b16 v[42:43], v10 offset:4352
    ds_read_b64_tr_b16 v[44:45], v10 offset:8192
    v_mfma_f32_32x32x16_bf16 v[80:95], v[120:123], v[184:187], v[80:95]
    ds_read_b64_tr_b16 v[46:47], v10 offset:8448
    s_waitcnt lgkmcnt(7)
    v_mfma_f32_32x32x16_bf16 v[48:63], v[24:27], v[188:191], v[48:63]
    ds_read_b128 v[196:199], v3 offset:0
    ds_read_b64_tr_b16 v[112:113], v10 offset:1024
    ds_read_b64_tr_b16 v[114:115], v10 offset:1280
    v_mfma_f32_32x32x16_bf16 v[64:79], v[28:31], v[188:191], v[64:79]
    ds_read_b64_tr_b16 v[116:117], v10 offset:5120
    ds_read_b64_tr_b16 v[118:119], v10 offset:5376
    ds_read_b64_tr_b16 v[120:121], v10 offset:9216
    v_mfma_f32_32x32x16_bf16 v[80:95], v[32:35], v[188:191], v[80:95]
    ds_read_b64_tr_b16 v[122:123], v10 offset:9472
    s_waitcnt lgkmcnt(7)
    v_mfma_f32_32x32x16_bf16 v[48:63], v[36:39], v[192:195], v[48:63]
    ds_read_b128 v[200:203], v4 offset:0
    ds_read_b64_tr_b16 v[24:25], v10 offset:2048
    ds_read_b64_tr_b16 v[26:27], v10 offset:2304
    v_mfma_f32_32x32x16_bf16 v[64:79], v[40:43], v[192:195], v[64:79]
    ds_read_b64_tr_b16 v[28:29], v10 offset:6144
    ds_read_b64_tr_b16 v[30:31], v10 offset:6400
    ds_read_b64_tr_b16 v[32:33], v10 offset:10240
    v_mfma_f32_32x32x16_bf16 v[80:95], v[44:47], v[192:195], v[80:95]
    ds_read_b64_tr_b16 v[34:35], v10 offset:10496
    s_waitcnt lgkmcnt(7)
    v_mfma_f32_32x32x16_bf16 v[48:63], v[112:115], v[196:199], v[48:63]
    ds_read_b128 v[204:207], v5 offset:0
    ds_read_b64_tr_b16 v[36:37], v10 offset:3072
    ds_read_b64_tr_b16 v[38:39], v10 offset:3328
    v_mfma_f32_32x32x16_bf16 v[64:79], v[116:119], v[196:199], v[64:79]
    ds_read_b64_tr_b16 v[40:41], v10 offset:7168
    ds_read_b64_tr_b16 v[42:43], v10 offset:7424
    ds_read_b64_tr_b16 v[44:45], v10 offset:11264
    v_mfma_f32_32x32x16_bf16 v[80:95], v[120:123], v[196:199], v[80:95]
    ds_read_b64_tr_b16 v[46:47], v10 offset:11520
    s_waitcnt lgkmcnt(0)
    s_barrier
    v_mfma_f32_32x32x16_bf16 v[48:63], v[24:27], v[200:203], v[48:63]
    ds_read_b128 v[208:211], v2 offset:16384
    ds_read_b64_tr_b16 v[112:113], v10 offset:16384
    ds_read_b64_tr_b16 v[114:115], v10 offset:16640
    v_mfma_f32_32x32x16_bf16 v[64:79], v[28:31], v[200:203], v[64:79]
    ds_read_b64_tr_b16 v[116:117], v10 offset:20480
    ds_read_b64_tr_b16 v[118:119], v10 offset:20736
    ds_read_b64_tr_b16 v[120:121], v10 offset:24576
    v_mfma_f32_32x32x16_bf16 v[80:95], v[32:35], v[200:203], v[80:95]
    ds_read_b64_tr_b16 v[122:123], v10 offset:24832
    s_waitcnt lgkmcnt(7)
    v_mfma_f32_32x32x16_bf16 v[48:63], v[36:39], v[204:207], v[48:63]
    ds_read_b128 v[212:215], v3 offset:16384
    ds_read_b64_tr_b16 v[24:25], v10 offset:17408
    ds_read_b64_tr_b16 v[26:27], v10 offset:17664
    v_mfma_f32_32x32x16_bf16 v[64:79], v[40:43], v[204:207], v[64:79]
    ds_read_b64_tr_b16 v[28:29], v10 offset:21504
    ds_read_b64_tr_b16 v[30:31], v10 offset:21760
    ds_read_b64_tr_b16 v[32:33], v10 offset:25600
    v_mfma_f32_32x32x16_bf16 v[80:95], v[44:47], v[204:207], v[80:95]
    ds_read_b64_tr_b16 v[34:35], v10 offset:25856
    s_waitcnt lgkmcnt(7)
    v_mfma_f32_32x32x16_bf16 v[48:63], v[112:115], v[208:211], v[48:63]
    ds_read_b128 v[216:219], v4 offset:16384
    ds_read_b64_tr_b16 v[36:37], v10 offset:18432
    ds_read_b64_tr_b16 v[38:39], v10 offset:18688
    v_mfma_f32_32x32x16_bf16 v[64:79], v[116:119], v[208:211], v[64:79]
    ds_read_b64_tr_b16 v[40:41], v10 offset:22528
    ds_read_b64_tr_b16 v[42:43], v10 offset:22784
    ds_read_b64_tr_b16 v[44:45], v10 offset:26624
    v_mfma_f32_32x32x16_bf16 v[80:95], v[120:123], v[208:211], v[80:95]
    ds_read_b64_tr_b16 v[46:47], v10 offset:26880
    s_waitcnt lgkmcnt(7)
    v_mfma_f32_32x32x16_bf16 v[48:63], v[24:27], v[212:215], v[48:63]
    ds_read_b128 v[220:223], v5 offset:16384
    ds_read_b64_tr_b16 v[112:113], v10 offset:19456
    ds_read_b64_tr_b16 v[114:115], v10 offset:19712
    v_mfma_f32_32x32x16_bf16 v[64:79], v[28:31], v[212:215], v[64:79]
    ds_read_b64_tr_b16 v[116:117], v10 offset:23552
    ds_read_b64_tr_b16 v[118:119], v10 offset:23808
    ds_read_b64_tr_b16 v[120:121], v10 offset:27648
    v_mfma_f32_32x32x16_bf16 v[80:95], v[32:35], v[212:215], v[80:95]
    ds_read_b64_tr_b16 v[122:123], v10 offset:27904
    s_lshl2_add_u32 s64, s57, s62
    s_lshl_b32 s64, s64, 9
    s_add_u32 s22, s64, 16777216
    v_and_b32 v12, 31, v0
    v_lshlrev_b32 v12, 4, v12
    buffer_load_dwordx4 v[108:111], v12, s[48:51], s22 offen sc1
    s_waitcnt lgkmcnt(0)
    s_barrier
    v_mfma_f32_32x32x16_bf16 v[48:63], v[36:39], v[216:219], v[48:63]
    ds_read_b128 v[224:227], v2 offset:32768
    ds_read_b64_tr_b16 v[24:25], v10 offset:32768
    ds_read_b64_tr_b16 v[26:27], v10 offset:33024
    v_mfma_f32_32x32x16_bf16 v[64:79], v[40:43], v[216:219], v[64:79]
    ds_read_b64_tr_b16 v[28:29], v10 offset:36864
    ds_read_b64_tr_b16 v[30:31], v10 offset:37120
    ds_read_b64_tr_b16 v[32:33], v10 offset:40960
    v_mfma_f32_32x32x16_bf16 v[80:95], v[44:47], v[216:219], v[80:95]
    ds_read_b64_tr_b16 v[34:35], v10 offset:41216
    s_waitcnt lgkmcnt(7)
    v_mfma_f32_32x32x16_bf16 v[48:63], v[112:115], v[220:223], v[48:63]
    ds_read_b128 v[228:231], v3 offset:32768
    ds_read_b64_tr_b16 v[36:37], v10 offset:33792
    ds_read_b64_tr_b16 v[38:39], v10 offset:34048
    v_mfma_f32_32x32x16_bf16 v[64:79], v[116:119], v[220:223], v[64:79]
    ds_read_b64_tr_b16 v[40:41], v10 offset:37888
    ds_read_b64_tr_b16 v[42:43], v10 offset:38144
    ds_read_b64_tr_b16 v[44:45], v10 offset:41984
    v_mfma_f32_32x32x16_bf16 v[80:95], v[120:123], v[220:223], v[80:95]
    ds_read_b64_tr_b16 v[46:47], v10 offset:42240
    s_waitcnt lgkmcnt(7)
    v_mfma_f32_32x32x16_bf16 v[48:63], v[24:27], v[224:227], v[48:63]
    ds_read_b128 v[232:235], v4 offset:32768
    ds_read_b64_tr_b16 v[112:113], v10 offset:34816
    ds_read_b64_tr_b16 v[114:115], v10 offset:35072
    v_mfma_f32_32x32x16_bf16 v[64:79], v[28:31], v[224:227], v[64:79]
    ds_read_b64_tr_b16 v[116:117], v10 offset:38912
    ds_read_b64_tr_b16 v[118:119], v10 offset:39168
    ds_read_b64_tr_b16 v[120:121], v10 offset:43008
    v_mfma_f32_32x32x16_bf16 v[80:95], v[32:35], v[224:227], v[80:95]
    ds_read_b64_tr_b16 v[122:123], v10 offset:43264
    s_waitcnt lgkmcnt(7)
    v_mfma_f32_32x32x16_bf16 v[48:63], v[36:39], v[228:231], v[48:63]
    ds_read_b128 v[236:239], v5 offset:32768
    ds_read_b64_tr_b16 v[24:25], v10 offset:35840
    ds_read_b64_tr_b16 v[26:27], v10 offset:36096
    v_mfma_f32_32x32x16_bf16 v[64:79], v[40:43], v[228:231], v[64:79]
    ds_read_b64_tr_b16 v[28:29], v10 offset:39936
    ds_read_b64_tr_b16 v[30:31], v10 offset:40192
    ds_read_b64_tr_b16 v[32:33], v10 offset:44032
    v_mfma_f32_32x32x16_bf16 v[80:95], v[44:47], v[228:231], v[80:95]
    ds_read_b64_tr_b16 v[34:35], v10 offset:44288
    s_waitcnt lgkmcnt(0)
    s_barrier
    v_mfma_f32_32x32x16_bf16 v[48:63], v[112:115], v[232:235], v[48:63]
    ds_read_b128 v[240:243], v2 offset:49152
    ds_read_b64_tr_b16 v[36:37], v10 offset:49152
    ds_read_b64_tr_b16 v[38:39], v10 offset:49408
    v_mfma_f32_32x32x16_bf16 v[64:79], v[116:119], v[232:235], v[64:79]
    ds_read_b64_tr_b16 v[40:41], v10 offset:53248
    ds_read_b64_tr_b16 v[42:43], v10 offset:53504
    ds_read_b64_tr_b16 v[44:45], v10 offset:57344
    v_mfma_f32_32x32x16_bf16 v[80:95], v[120:123], v[232:235], v[80:95]
    ds_read_b64_tr_b16 v[46:47], v10 offset:57600
    s_waitcnt lgkmcnt(7)
    v_mfma_f32_32x32x16_bf16 v[48:63], v[24:27], v[236:239], v[48:63]
    ds_read_b128 v[244:247], v3 offset:49152
    ds_read_b64_tr_b16 v[112:113], v10 offset:50176
    ds_read_b64_tr_b16 v[114:115], v10 offset:50432
    v_mfma_f32_32x32x16_bf16 v[64:79], v[28:31], v[236:239], v[64:79]
    ds_read_b64_tr_b16 v[116:117], v10 offset:54272
    ds_read_b64_tr_b16 v[118:119], v10 offset:54528
    ds_read_b64_tr_b16 v[120:121], v10 offset:58368
    v_mfma_f32_32x32x16_bf16 v[80:95], v[32:35], v[236:239], v[80:95]
    ds_read_b64_tr_b16 v[122:123], v10 offset:58624
    s_waitcnt lgkmcnt(7)
    v_mfma_f32_32x32x16_bf16 v[48:63], v[36:39], v[240:243], v[48:63]
    ds_read_b128 v[248:251], v4 offset:49152
    ds_read_b64_tr_b16 v[24:25], v10 offset:51200
    ds_read_b64_tr_b16 v[26:27], v10 offset:51456
    v_mfma_f32_32x32x16_bf16 v[64:79], v[40:43], v[240:243], v[64:79]
    ds_read_b64_tr_b16 v[28:29], v10 offset:55296
    ds_read_b64_tr_b16 v[30:31], v10 offset:55552
    ds_read_b64_tr_b16 v[32:33], v10 offset:59392
    v_mfma_f32_32x32x16_bf16 v[80:95], v[44:47], v[240:243], v[80:95]
    ds_read_b64_tr_b16 v[34:35], v10 offset:59648
    s_waitcnt lgkmcnt(7)
    v_mfma_f32_32x32x16_bf16 v[48:63], v[112:115], v[244:247], v[48:63]
    ds_read_b128 v[252:255], v5 offset:49152
    ds_read_b64_tr_b16 v[36:37], v10 offset:52224
    ds_read_b64_tr_b16 v[38:39], v10 offset:52480
    v_mfma_f32_32x32x16_bf16 v[64:79], v[116:119], v[244:247], v[64:79]
    ds_read_b64_tr_b16 v[40:41], v10 offset:56320
    ds_read_b64_tr_b16 v[42:43], v10 offset:56576
    ds_read_b64_tr_b16 v[44:45], v10 offset:60416
    v_mfma_f32_32x32x16_bf16 v[80:95], v[120:123], v[244:247], v[80:95]
    ds_read_b64_tr_b16 v[46:47], v10 offset:60672
    s_waitcnt lgkmcnt(7)
    v_mfma_f32_32x32x16_bf16 v[48:63], v[24:27], v[248:251], v[48:63]
    v_mfma_f32_32x32x16_bf16 v[64:79], v[28:31], v[248:251], v[64:79]
    v_mfma_f32_32x32x16_bf16 v[80:95], v[32:35], v[248:251], v[80:95]
    v_cmp_gt_u32 vcc, 32, v0
    s_lshl_b32 s64, s62, 10
    s_add_u32 s65, s64, 139264
    v_add_u32 v2, s65, v13
    s_add_u32 s65, s64, 57344
    v_add_u32 v3, s65, v14
    s_add_u32 s65, s64, 61440
    v_add_u32 v10, s65, v13
    v_mov_b32 v4, 158720
    v_mov_b32 v5, 1
    s_waitcnt lgkmcnt(0)
    v_mfma_f32_32x32x16_bf16 v[48:63], v[36:39], v[252:255], v[48:63]
    v_mfma_f32_32x32x16_bf16 v[64:79], v[40:43], v[252:255], v[64:79]
    v_mfma_f32_32x32x16_bf16 v[80:95], v[44:47], v[252:255], v[80:95]
    s_setprio 1
    ds_read_b32 v96, v11 offset:0
    ds_read_b32 v100, v11 offset:128
    ds_read_b32 v104, v11 offset:256
    s_mov_b32 s77, 1
    s_mov_b32 s82, 0
    s_waitcnt vmcnt(0)
L_rsr_226:
    v_cmp_ne_u64 s[66:67], s[80:81], v[110:111]
    s_nop 0
    s_cmp_lg_u64 s[66:67], 0
    s_cbranch_scc1 L_rs_225
L_rsx_227:
    v_cndmask_b32 v20, 0, v108, vcc
    v_mov_b32 v16, v109
    v_mul_f32 v17, 0x3eb8aa3b, v109
    s_waitcnt lgkmcnt(0)
    v_mfma_f32_32x32x16_bf16 v[64:79], v[100:103], v[20:23], v[64:79]
    v_mfma_f32_32x32x16_bf16 v[80:95], v[104:107], v[20:23], v[80:95]
    v_mfma_f32_32x32x16_bf16 v[48:63], v[96:99], v[20:23], v[48:63]
    s_nop 9
    v_mul_f32 v64, v16, v64
    v_mul_f32 v65, v16, v65
    v_mul_f32 v66, v16, v66
    v_mul_f32 v67, v16, v67
    v_mul_f32 v68, v16, v68
    v_mul_f32 v69, v16, v69
    v_mul_f32 v70, v16, v70
    v_mul_f32 v71, v16, v71
    v_cvt_pk_bf16_f32 v64, v64, v65
    v_cvt_pk_bf16_f32 v65, v66, v67
    v_cvt_pk_bf16_f32 v66, v68, v69
    v_cvt_pk_bf16_f32 v67, v70, v71
    s_add_u32 s79, s68, 0
    buffer_store_dwordx4 v[64:67], v13, s[48:51], s79 offen sc1
    v_mul_f32 v72, v16, v72
    v_mul_f32 v73, v16, v73
    v_mul_f32 v74, v16, v74
    v_mul_f32 v75, v16, v75
    v_mul_f32 v76, v16, v76
    v_mul_f32 v77, v16, v77
    v_mul_f32 v78, v16, v78
    v_mul_f32 v79, v16, v79
    v_cvt_pk_bf16_f32 v68, v72, v73
    v_cvt_pk_bf16_f32 v69, v74, v75
    v_cvt_pk_bf16_f32 v70, v76, v77
    v_cvt_pk_bf16_f32 v71, v78, v79
    s_barrier
    ds_read_b64_tr_b16 v[24:25], v6 offset:0
    ds_read_b64_tr_b16 v[26:27], v6 offset:512
    ds_read_b64_tr_b16 v[28:29], v7 offset:0
    ds_read_b64_tr_b16 v[30:31], v7 offset:512
    ds_read_b64_tr_b16 v[32:33], v6 offset:2048
    ds_read_b64_tr_b16 v[34:35], v6 offset:2560
    ds_read_b64_tr_b16 v[36:37], v7 offset:2048
    ds_read_b64_tr_b16 v[38:39], v7 offset:2560
    ds_read_b64_tr_b16 v[40:41], v6 offset:4096
    ds_read_b64_tr_b16 v[42:43], v6 offset:4608
    s_add_u32 s79, s68, 65536
    buffer_store_dwordx4 v[68:71], v13, s[48:51], s79 offen sc1
    v_mul_f32 v80, v16, v80
    v_mul_f32 v81, v16, v81
    v_mul_f32 v82, v16, v82
    v_mul_f32 v83, v16, v83
    v_mul_f32 v84, v16, v84
    v_mul_f32 v85, v16, v85
    s_waitcnt lgkmcnt(8)
    v_mfma_f32_32x32x16_bf16 v[96:111], v[24:27], v[128:131], 0
    ds_read_b64_tr_b16 v[44:45], v7 offset:4096
    ds_read_b64_tr_b16 v[46:47], v7 offset:4608
    v_mul_f32 v86, v16, v86
    v_mul_f32 v87, v16, v87
    v_cvt_pk_bf16_f32 v80, v80, v81
    v_cvt_pk_bf16_f32 v81, v82, v83
    v_cvt_pk_bf16_f32 v82, v84, v85
    s_waitcnt lgkmcnt(8)
    v_mfma_f32_32x32x16_bf16 v[112:127], v[28:31], v[128:131], 0
    ds_read_b64_tr_b16 v[24:25], v6 offset:6144
    ds_read_b64_tr_b16 v[26:27], v6 offset:6656
    v_cvt_pk_bf16_f32 v83, v86, v87
    s_add_u32 s79, s69, 0
    buffer_store_dwordx4 v[80:83], v14, s[48:51], s79 offen sc1
    v_mul_f32 v88, v16, v88
    v_mul_f32 v89, v16, v89
    s_waitcnt lgkmcnt(8)
    v_mfma_f32_32x32x16_bf16 v[96:111], v[32:35], v[132:135], v[96:111]
    ds_read_b64_tr_b16 v[28:29], v7 offset:6144
    ds_read_b64_tr_b16 v[30:31], v7 offset:6656
    v_mul_f32 v90, v16, v90
    v_mul_f32 v91, v16, v91
    v_mul_f32 v92, v16, v92
    v_mul_f32 v93, v16, v93
    v_mul_f32 v94, v16, v94
    s_waitcnt lgkmcnt(8)
    v_mfma_f32_32x32x16_bf16 v[112:127], v[36:39], v[132:135], v[112:127]
    ds_read_b64_tr_b16 v[32:33], v6 offset:8192
    ds_read_b64_tr_b16 v[34:35], v6 offset:8704
    v_mul_f32 v95, v16, v95
    v_cvt_pk_bf16_f32 v84, v88, v89
    v_cvt_pk_bf16_f32 v85, v90, v91
    v_cvt_pk_bf16_f32 v86, v92, v93
    v_cvt_pk_bf16_f32 v87, v94, v95
    s_waitcnt lgkmcnt(8)
    v_mfma_f32_32x32x16_bf16 v[96:111], v[40:43], v[136:139], v[96:111]
    ds_read_b64_tr_b16 v[36:37], v7 offset:8192
    ds_read_b64_tr_b16 v[38:39], v7 offset:8704
    s_add_u32 s79, s69, 65536
    buffer_store_dwordx4 v[84:87], v14, s[48:51], s79 offen sc1
    s_mov_b32 s77, 0
    v_mul_f32 v48, v17, v48
    v_mul_f32 v49, v17, v49
    s_waitcnt lgkmcnt(8)
    v_mfma_f32_32x32x16_bf16 v[112:127], v[44:47], v[136:139], v[112:127]
    ds_read_b64_tr_b16 v[40:41], v6 offset:10240
    ds_read_b64_tr_b16 v[42:43], v6 offset:10752
    v_mul_f32 v50, v17, v50
    v_mul_f32 v51, v17, v51
    v_mul_f32 v52, v17, v52
    v_mul_f32 v53, v17, v53
    v_mul_f32 v54, v17, v54
    s_waitcnt lgkmcnt(8)
    v_mfma_f32_32x32x16_bf16 v[96:111], v[24:27], v[140:143], v[96:111]
    ds_read_b64_tr_b16 v[44:45], v7 offset:10240
    ds_read_b64_tr_b16 v[46:47], v7 offset:10752
    v_mul_f32 v55, v17, v55
    v_cvt_pk_bf16_f32 v48, v48, v49
    v_cvt_pk_bf16_f32 v49, v50, v51
    v_cvt_pk_bf16_f32 v50, v52, v53
    v_cvt_pk_bf16_f32 v51, v54, v55
    s_waitcnt lgkmcnt(8)
    v_mfma_f32_32x32x16_bf16 v[112:127], v[28:31], v[140:143], v[112:127]
    ds_read_b64_tr_b16 v[24:25], v6 offset:12288
    ds_read_b64_tr_b16 v[26:27], v6 offset:12800
    v_mul_f32 v56, v17, v56
    v_mul_f32 v57, v17, v57
    v_mul_f32 v58, v17, v58
    v_mul_f32 v59, v17, v59
    v_mul_f32 v60, v17, v60
    s_waitcnt lgkmcnt(8)
    v_mfma_f32_32x32x16_bf16 v[96:111], v[32:35], v[144:147], v[96:111]
    ds_read_b64_tr_b16 v[28:29], v7 offset:12288
    ds_read_b64_tr_b16 v[30:31], v7 offset:12800
    v_mul_f32 v61, v17, v61
    v_mul_f32 v62, v17, v62
    v_mul_f32 v63, v17, v63
    v_cvt_pk_bf16_f32 v52, v56, v57
    v_cvt_pk_bf16_f32 v53, v58, v59
    s_waitcnt lgkmcnt(8)
    v_mfma_f32_32x32x16_bf16 v[112:127], v[36:39], v[144:147], v[112:127]
    ds_read_b64_tr_b16 v[32:33], v6 offset:14336
    ds_read_b64_tr_b16 v[34:35], v6 offset:14848
    v_cvt_pk_bf16_f32 v54, v60, v61
    v_cvt_pk_bf16_f32 v55, v62, v63
    s_waitcnt lgkmcnt(8)
    v_mfma_f32_32x32x16_bf16 v[96:111], v[40:43], v[148:151], v[96:111]
    ds_write_b128 v2, v[64:67]
    ds_write_b128 v2, v[68:71] offset:12288
    ds_read_b64_tr_b16 v[36:37], v7 offset:14336
    ds_read_b64_tr_b16 v[38:39], v7 offset:14848
    s_getreg_b32 s64, hwreg(HW_REG_IB_STS)
    s_and_b32 s64, s64, 0xc0000f
    s_or_b32 s64, s64, s77
    s_cbranch_scc0 L_pub_228
L_pubr_229:
    s_waitcnt lgkmcnt(10)
    v_mfma_f32_32x32x16_bf16 v[112:127], v[44:47], v[148:151], v[112:127]
    ds_write_b128 v3, v[80:83]
    ds_write_b128 v10, v[48:51]
    ds_read_b64_tr_b16 v[40:41], v8 offset:0
    ds_read_b64_tr_b16 v[42:43], v8 offset:512
    s_waitcnt lgkmcnt(12)
    v_mfma_f32_32x32x16_bf16 v[96:111], v[24:27], v[152:155], v[96:111]
    v_add_u32 v3, 65536, v3
    v_add_u32 v10, 65536, v10
    ds_write_b128 v3, v[84:87]
    ds_write_b128 v10, v[52:55]
    ds_read_b64_tr_b16 v[44:45], v9 offset:0
    ds_read_b64_tr_b16 v[46:47], v9 offset:512
    s_waitcnt lgkmcnt(14)
    v_mfma_f32_32x32x16_bf16 v[112:127], v[28:31], v[152:155], v[112:127]
    s_mov_b64 exec, 1
    ds_add_u32 v4, v5 offset:24
    s_mov_b64 exec, -1
    ds_read_b64_tr_b16 v[24:25], v8 offset:2048
    ds_read_b64_tr_b16 v[26:27], v8 offset:2560
    s_waitcnt lgkmcnt(15)
    v_mfma_f32_32x32x16_bf16 v[96:111], v[32:35], v[156:159], v[96:111]
    ds_read_b64_tr_b16 v[28:29], v9 offset:2048
    ds_read_b64_tr_b16 v[30:31], v9 offset:2560
    s_waitcnt lgkmcnt(13)
    v_mfma_f32_32x32x16_bf16 v[112:127], v[36:39], v[156:159], v[112:127]
    ds_read_b64_tr_b16 v[32:33], v8 offset:4096
    ds_read_b64_tr_b16 v[34:35], v8 offset:4608
    v_mov_b32 v81, 0
    v_mov_b32 v82, 0
    s_getreg_b32 s64, hwreg(HW_REG_IB_STS)
    s_and_b32 s64, s64, 0xc0000f
    s_or_b32 s64, s64, s77
    s_cbranch_scc0 L_pub_230
L_pubr_231:
    s_waitcnt lgkmcnt(11)
    v_mfma_f32_32x32x16_bf16 v[96:111], v[40:43], v[160:163], v[96:111]
    ds_read_b64_tr_b16 v[36:37], v9 offset:4096
    ds_read_b64_tr_b16 v[38:39], v9 offset:4608
    v_mov_b32 v83, 0
    v_mov_b32 v85, 0
    s_waitcnt lgkmcnt(9)
    v_mfma_f32_32x32x16_bf16 v[112:127], v[44:47], v[160:163], v[112:127]
    ds_read_b64_tr_b16 v[40:41], v8 offset:6144
    ds_read_b64_tr_b16 v[42:43], v8 offset:6656
    v_mov_b32 v86, 0
    v_mov_b32 v87, 0
    s_waitcnt lgkmcnt(8)
    v_mfma_f32_32x32x16_bf16 v[96:111], v[24:27], v[164:167], v[96:111]
    ds_read_b64_tr_b16 v[44:45], v9 offset:6144
    ds_read_b64_tr_b16 v[46:47], v9 offset:6656
    v_bfe_u32 v95, v0, 4, 1
    v_lshlrev_b32 v95, 2, v95
    s_waitcnt lgkmcnt(8)
    v_mfma_f32_32x32x16_bf16 v[112:127], v[28:31], v[164:167], v[112:127]
    ds_read_b64_tr_b16 v[24:25], v8 offset:8192
    ds_read_b64_tr_b16 v[26:27], v8 offset:8704
    v_and_b32 v2, 7, v0
    v_xor_b32 v2, v2, v95
    s_waitcnt lgkmcnt(8)
    v_mfma_f32_32x32x16_bf16 v[96:111], v[32:35], v[168:171], v[96:111]
    ds_read_b64_tr_b16 v[28:29], v9 offset:8192
    ds_read_b64_tr_b16 v[30:31], v9 offset:8704
    v_lshlrev_b32 v2, 4, v2
    v_lshrrev_b32 v95, 3, v0
    s_getreg_b32 s64, hwreg(HW_REG_IB_STS)
    s_and_b32 s64, s64, 0xc0000f
    s_or_b32 s64, s64, s77
    s_cbranch_scc0 L_pub_232
L_pubr_233:
    s_waitcnt lgkmcnt(8)
    v_mfma_f32_32x32x16_bf16 v[112:127], v[36:39], v[168:171], v[112:127]
    ds_read_b64_tr_b16 v[32:33], v8 offset:10240
    ds_read_b64_tr_b16 v[34:35], v8 offset:10752
    v_mul_u32_u24 v95, 1024, v95
    v_add_u32 v2, v2, v95
    s_waitcnt lgkmcnt(8)
    v_mfma_f32_32x32x16_bf16 v[96:111], v[40:43], v[172:175], v[96:111]
    ds_read_b64_tr_b16 v[36:37], v9 offset:10240
    ds_read_b64_tr_b16 v[38:39], v9 offset:10752
    v_lshrrev_b32 v3, 5, v0
    v_lshlrev_b32 v3, 10, v3
    s_waitcnt lgkmcnt(8)
    v_mfma_f32_32x32x16_bf16 v[112:127], v[44:47], v[172:175], v[112:127]
    ds_read_b64_tr_b16 v[40:41], v8 offset:12288
    ds_read_b64_tr_b16 v[42:43], v8 offset:12800
    v_bfe_u32 v95, v0, 2, 2
    v_lshl_add_u32 v3, v95, 7, v3
    s_waitcnt lgkmcnt(8)
    v_mfma_f32_32x32x16_bf16 v[96:111], v[24:27], v[176:179], v[96:111]
    ds_read_b64_tr_b16 v[44:45], v9 offset:12288
    ds_read_b64_tr_b16 v[46:47], v9 offset:12800
    v_bfe_u32 v95, v0, 3, 1
    v_lshl_add_u32 v3, v95, 6, v3
    s_waitcnt lgkmcnt(8)
    v_mfma_f32_32x32x16_bf16 v[112:127], v[28:31], v[176:179], v[112:127]
    ds_read_b64_tr_b16 v[24:25], v8 offset:14336
    ds_read_b64_tr_b16 v[26:27], v8 offset:14848
    v_bfe_u32 v95, v0, 4, 1
    v_lshl_add_u32 v3, v95, 4, v3
    s_getreg_b32 s64, hwreg(HW_REG_IB_STS)
    s_and_b32 s64, s64, 0xc0000f
    s_or_b32 s64, s64, s77
    s_cbranch_scc0 L_pub_234
L_pubr_235:
    s_waitcnt lgkmcnt(8)
    v_mfma_f32_32x32x16_bf16 v[96:111], v[32:35], v[180:183], v[96:111]
    ds_read_b64_tr_b16 v[28:29], v9 offset:14336
    ds_read_b64_tr_b16 v[30:31], v9 offset:14848
    v_bfe_u32 v95, v0, 0, 1
    v_lshl_add_u32 v3, v95, 5, v3
    s_waitcnt lgkmcnt(0)
    s_barrier
    v_mfma_f32_32x32x16_bf16 v[112:127], v[36:39], v[180:183], v[112:127]
    ds_read_b64_tr_b16 v[32:33], v6 offset:16384
    ds_read_b64_tr_b16 v[34:35], v6 offset:16896
    v_bfe_u32 v95, v0, 1, 1
    v_lshl_add_u32 v3, v95, 3, v3
    s_waitcnt lgkmcnt(8)
    v_mfma_f32_32x32x16_bf16 v[96:111], v[40:43], v[184:187], v[96:111]
    ds_read_b64_tr_b16 v[36:37], v7 offset:16384
    ds_read_b64_tr_b16 v[38:39], v7 offset:16896
    s_and_b32 s65, s62, 1
    s_lshl_b32 s28, s65, 16
    s_waitcnt lgkmcnt(8)
    v_mfma_f32_32x32x16_bf16 v[112:127], v[44:47], v[184:187], v[112:127]
    ds_read_b64_tr_b16 v[40:41], v6 offset:18432
    ds_read_b64_tr_b16 v[42:43], v6 offset:18944
    s_lshr_b32 s65, s62, 1
    s_lshr_b32 s65, 0x8000, s65
    s_waitcnt lgkmcnt(8)
    v_mfma_f32_32x32x16_bf16 v[96:111], v[24:27], v[188:191], v[96:111]
    ds_read_b64_tr_b16 v[44:45], v7 offset:18432
    ds_read_b64_tr_b16 v[46:47], v7 offset:18944
    s_add_u32 s28, s28, s65
    v_add_u32 v3, s28, v3
    s_getreg_b32 s64, hwreg(HW_REG_IB_STS)
    s_and_b32 s64, s64, 0xc0000f
    s_or_b32 s64, s64, s77
    s_cbranch_scc0 L_pub_236
L_pubr_237:
    s_waitcnt lgkmcnt(8)
    v_mfma_f32_32x32x16_bf16 v[112:127], v[28:31], v[188:191], v[112:127]
    ds_read_b64_tr_b16 v[24:25], v6 offset:20480
    ds_read_b64_tr_b16 v[26:27], v6 offset:20992
    v_xor_b32 v4, 64, v3
    s_mul_i32 s29, s60, 294912
    s_waitcnt lgkmcnt(8)
    v_mfma_f32_32x32x16_bf16 v[96:111], v[32:35], v[192:195], v[96:111]
    ds_read_b64_tr_b16 v[28:29], v7 offset:20480
    ds_read_b64_tr_b16 v[30:31], v7 offset:20992
    s_lshl_b32 s65, s61, 7
    s_mul_i32 s22, s62, 458752
    s_waitcnt lgkmcnt(8)
    v_mfma_f32_32x32x16_bf16 v[112:127], v[36:39], v[192:195], v[112:127]
    ds_read_b64_tr_b16 v[32:33], v6 offset:22528
    ds_read_b64_tr_b16 v[34:35], v6 offset:23040
    s_add_u32 s22, s22, s65
    s_lshl_b32 s23, s62, 17
    s_waitcnt lgkmcnt(8)
    v_mfma_f32_32x32x16_bf16 v[96:111], v[40:43], v[196:199], v[96:111]
    ds_read_b64_tr_b16 v[36:37], v7 offset:22528
    ds_read_b64_tr_b16 v[38:39], v7 offset:23040
    s_add_u32 s23, s23, s65
    v_and_b32 v5, 1, v0
    s_waitcnt lgkmcnt(8)
    v_mfma_f32_32x32x16_bf16 v[112:127], v[44:47], v[196:199], v[112:127]
    ds_read_b64_tr_b16 v[40:41], v6 offset:24576
    ds_read_b64_tr_b16 v[42:43], v6 offset:25088
    v_lshlrev_b32 v5, 12, v5
    v_lshrrev_b32 v95, 1, v0
    s_getreg_b32 s64, hwreg(HW_REG_IB_STS)
    s_and_b32 s64, s64, 0xc0000f
    s_or_b32 s64, s64, s77
    s_cbranch_scc0 L_pub_238
L_pubr_239:
    s_waitcnt lgkmcnt(8)
    v_mfma_f32_32x32x16_bf16 v[96:111], v[24:27], v[200:203], v[96:111]
    ds_read_b64_tr_b16 v[44:45], v7 offset:24576
    ds_read_b64_tr_b16 v[46:47], v7 offset:25088
    v_lshl_add_u32 v5, v95, 7, v5
    s_lshl_b32 s65, s60, 13
    s_waitcnt lgkmcnt(8)
    v_mfma_f32_32x32x16_bf16 v[112:127], v[28:31], v[200:203], v[112:127]
    ds_read_b64_tr_b16 v[24:25], v6 offset:26624
    ds_read_b64_tr_b16 v[26:27], v6 offset:27136
    s_lshl_b32 s66, s62, 9
    s_add_u32 s65, s65, s66
    s_waitcnt lgkmcnt(8)
    v_mfma_f32_32x32x16_bf16 v[96:111], v[32:35], v[204:207], v[96:111]
    ds_read_b64_tr_b16 v[28:29], v7 offset:26624
    ds_read_b64_tr_b16 v[30:31], v7 offset:27136
    s_add_u32 s65, s65, 15990784
    v_add_u32 v5, s65, v5
    s_waitcnt lgkmcnt(8)
    v_mfma_f32_32x32x16_bf16 v[112:127], v[36:39], v[204:207], v[112:127]
    ds_read_b64_tr_b16 v[32:33], v6 offset:28672
    ds_read_b64_tr_b16 v[34:35], v6 offset:29184
    v_and_b32 v10, 31, v0
    v_lshlrev_b32 v10, 10, v10
    s_waitcnt lgkmcnt(8)
    v_mfma_f32_32x32x16_bf16 v[96:111], v[40:43], v[208:211], v[96:111]
    ds_read_b64_tr_b16 v[36:37], v7 offset:28672
    ds_read_b64_tr_b16 v[38:39], v7 offset:29184
    v_lshrrev_b32 v95, 5, v0
    v_lshl_add_u32 v10, v95, 5, v10
    s_getreg_b32 s64, hwreg(HW_REG_IB_STS)
    s_and_b32 s64, s64, 0xc0000f
    s_or_b32 s64, s64, s77
    s_cbranch_scc0 L_pub_240
L_pubr_241:
    s_waitcnt lgkmcnt(8)
    v_mfma_f32_32x32x16_bf16 v[112:127], v[44:47], v[208:211], v[112:127]
    ds_read_b64_tr_b16 v[40:41], v6 offset:30720
    ds_read_b64_tr_b16 v[42:43], v6 offset:31232
    s_lshl_b32 s65, s60, 16
    s_and_b32 s66, s62, 1
    s_waitcnt lgkmcnt(8)
    v_mfma_f32_32x32x16_bf16 v[96:111], v[24:27], v[212:215], v[96:111]
    ds_read_b64_tr_b16 v[44:45], v7 offset:30720
    ds_read_b64_tr_b16 v[46:47], v7 offset:31232
    s_lshl_b32 s66, s66, 15
    s_add_u32 s65, s65, s66
    s_waitcnt lgkmcnt(8)
    v_mfma_f32_32x32x16_bf16 v[112:127], v[28:31], v[212:215], v[112:127]
    ds_read_b64_tr_b16 v[24:25], v8 offset:16384
    ds_read_b64_tr_b16 v[26:27], v8 offset:16896
    s_lshl_b32 s66, s61, 7
    s_add_u32 s65, s65, s66
    s_waitcnt lgkmcnt(8)
    v_mfma_f32_32x32x16_bf16 v[96:111], v[32:35], v[216:219], v[96:111]
    ds_read_b64_tr_b16 v[28:29], v9 offset:16384
    ds_read_b64_tr_b16 v[30:31], v9 offset:16896
    s_lshr_b32 s66, s62, 1
    s_lshl_b32 s66, s66, 6
    s_waitcnt lgkmcnt(8)
    v_mfma_f32_32x32x16_bf16 v[112:127], v[36:39], v[216:219], v[112:127]
    ds_read_b64_tr_b16 v[32:33], v8 offset:18432
    ds_read_b64_tr_b16 v[34:35], v8 offset:18944
    s_add_u32 s65, s65, s66
    v_add_u32 v10, s65, v10
    s_getreg_b32 s64, hwreg(HW_REG_IB_STS)
    s_and_b32 s64, s64, 0xc0000f
    s_or_b32 s64, s64, s77
    s_cbranch_scc0 L_pub_242
L_pubr_243:
    s_waitcnt lgkmcnt(8)
    v_mfma_f32_32x32x16_bf16 v[96:111], v[40:43], v[220:223], v[96:111]
    ds_read_b64_tr_b16 v[36:37], v9 offset:18432
    ds_read_b64_tr_b16 v[38:39], v9 offset:18944
    v_add_u32 v17, 147456, v13
    s_mul_i32 s3, s61, 3
    s_waitcnt lgkmcnt(8)
    v_mfma_f32_32x32x16_bf16 v[112:127], v[44:47], v[220:223], v[112:127]
    ds_read_b64_tr_b16 v[40:41], v8 offset:20480
    ds_read_b64_tr_b16 v[42:43], v8 offset:20992
    s_lshr_b32 s3, s3, 1
    s_and_b32 s65, s60, 1
    s_waitcnt lgkmcnt(8)
    v_mfma_f32_32x32x16_bf16 v[96:111], v[24:27], v[224:227], v[96:111]
    ds_read_b64_tr_b16 v[44:45], v9 offset:20480
    ds_read_b64_tr_b16 v[46:47], v9 offset:20992
    s_mul_i32 s65, s65, 6
    s_add_u32 s3, s3, s65
    s_waitcnt lgkmcnt(8)
    v_mfma_f32_32x32x16_bf16 v[112:127], v[28:31], v[224:227], v[112:127]
    ds_read_b64_tr_b16 v[24:25], v8 offset:22528
    ds_read_b64_tr_b16 v[26:27], v8 offset:23040
    s_and_b32 s63, s60, 0
    s_lshl_b32 s63, s63, 2
    s_waitcnt lgkmcnt(8)
    v_mfma_f32_32x32x16_bf16 v[96:111], v[32:35], v[228:231], v[96:111]
    ds_read_b64_tr_b16 v[28:29], v9 offset:22528
    ds_read_b64_tr_b16 v[30:31], v9 offset:23040
    s_add_u32 s63, s63, s61
    s_lshl_b32 s63, s63, 1
    s_getreg_b32 s64, hwreg(HW_REG_IB_STS)
    s_and_b32 s64, s64, 0xc0000f
    s_or_b32 s64, s64, s77
    s_cbranch_scc0 L_pub_244
L_pubr_245:
    s_waitcnt lgkmcnt(8)
    v_mfma_f32_32x32x16_bf16 v[112:127], v[36:39], v[228:231], v[112:127]
    ds_read_b64_tr_b16 v[32:33], v8 offset:24576
    ds_read_b64_tr_b16 v[34:35], v8 offset:25088
    s_waitcnt lgkmcnt(8)
    v_mfma_f32_32x32x16_bf16 v[96:111], v[40:43], v[232:235], v[96:111]
    ds_read_b64_tr_b16 v[36:37], v9 offset:24576
    ds_read_b64_tr_b16 v[38:39], v9 offset:25088
    s_waitcnt lgkmcnt(8)
    v_mfma_f32_32x32x16_bf16 v[112:127], v[44:47], v[232:235], v[112:127]
    ds_read_b64_tr_b16 v[40:41], v8 offset:26624
    ds_read_b64_tr_b16 v[42:43], v8 offset:27136
    s_waitcnt lgkmcnt(8)
    v_mfma_f32_32x32x16_bf16 v[96:111], v[24:27], v[236:239], v[96:111]
    ds_read_b64_tr_b16 v[44:45], v9 offset:26624
    ds_read_b64_tr_b16 v[46:47], v9 offset:27136
    s_waitcnt lgkmcnt(8)
    v_mfma_f32_32x32x16_bf16 v[112:127], v[28:31], v[236:239], v[112:127]
    ds_read_b64_tr_b16 v[24:25], v8 offset:28672
    ds_read_b64_tr_b16 v[26:27], v8 offset:29184
    s_getreg_b32 s64, hwreg(HW_REG_IB_STS)
    s_and_b32 s64, s64, 0xc0000f
    s_or_b32 s64, s64, s77
    s_cbranch_scc0 L_pub_246
L_pubr_247:
    s_waitcnt lgkmcnt(8)
    v_mfma_f32_32x32x16_bf16 v[96:111], v[32:35], v[240:243], v[96:111]
    ds_read_b64_tr_b16 v[28:29], v9 offset:28672
    ds_read_b64_tr_b16 v[30:31], v9 offset:29184
    s_waitcnt lgkmcnt(8)
    v_mfma_f32_32x32x16_bf16 v[112:127], v[36:39], v[240:243], v[112:127]
    ds_read_b64_tr_b16 v[32:33], v8 offset:30720
    ds_read_b64_tr_b16 v[34:35], v8 offset:31232
    s_waitcnt lgkmcnt(8)
    v_mfma_f32_32x32x16_bf16 v[96:111], v[40:43], v[244:247], v[96:111]
    ds_read_b64_tr_b16 v[36:37], v9 offset:30720
    ds_read_b64_tr_b16 v[38:39], v9 offset:31232
    s_waitcnt lgkmcnt(8)
    v_mfma_f32_32x32x16_bf16 v[112:127], v[44:47], v[244:247], v[112:127]
    s_waitcnt lgkmcnt(6)
    v_mfma_f32_32x32x16_bf16 v[96:111], v[24:27], v[248:251], v[96:111]
    s_getreg_b32 s64, hwreg(HW_REG_IB_STS)
    s_and_b32 s64, s64, 0xc0000f
    s_or_b32 s64, s64, s77
    s_cbranch_scc0 L_pub_248
L_pubr_249:
    s_waitcnt lgkmcnt(4)
    v_mfma_f32_32x32x16_bf16 v[112:127], v[28:31], v[248:251], v[112:127]
    s_cmp_eq_u32 s77, 0
    s_cbranch_scc1 L_pub_250
L_pubr_251:
    v_mov_b32 v90, 158720
    v_mov_b32 v91, 1
    s_waitcnt lgkmcnt(2)
    v_mfma_f32_32x32x16_bf16 v[96:111], v[32:35], v[252:255], v[96:111]
    s_sub_u32 s65, s3, 12
    s_cmp_ge_u32 s3, 12
    s_cselect_b32 s3, s65, s3
    s_waitcnt lgkmcnt(0)
    v_mfma_f32_32x32x16_bf16 v[112:127], v[36:39], v[252:255], v[112:127]
    s_mov_b64 exec, 1
    ds_add_u32 v90, v91 offset:20
    s_mov_b64 exec, -1
    s_mov_b32 s82, 0
L_s3_252:
    ds_read_b32 v92, v90 offset:16
    s_add_u32 s82, s82, 1
    s_waitcnt lgkmcnt(0)
    v_readfirstlane_b32 s64, v92
    s_nop 0
    s_cmp_ge_u32 s64, 2
    s_cbranch_scc1 L_s3d_253
    s_cmp_gt_u32 s82, 480000
    s_cbranch_scc1 L_s3d_253
    s_sleep 2
    s_branch L_s3_252
L_s3d_253:
    v_xor_b32 v6, s76, v6
    v_xor_b32 v8, s76, v8
    ds_read_b32 v80, v11 offset:512
    ds_read_b32 v84, v11 offset:640
    s_add_u32 s78, s72, 262144
    s_mov_b32 s77, 1
    s_and_b32 s64, s58, 3
    s_cmp_eq_u32 s64, 1
    s_cbranch_scc1 L_fb1_254
    s_cmp_eq_u32 s64, 2
    s_cbranch_scc1 L_fb1_254
    ds_read_b64_tr_b16 v[24:25], v6 offset:32768
    ds_read_b64_tr_b16 v[26:27], v6 offset:33280
    ds_read_b64_tr_b16 v[28:29], v7 offset:32768
    ds_read_b64_tr_b16 v[30:31], v7 offset:33280
    ds_read_b64_tr_b16 v[32:33], v6 offset:34816
    ds_read_b64_tr_b16 v[34:35], v6 offset:35328
    ds_read_b64_tr_b16 v[36:37], v7 offset:34816
    ds_read_b64_tr_b16 v[38:39], v7 offset:35328
    ds_read_b64_tr_b16 v[40:41], v6 offset:36864
    ds_read_b64_tr_b16 v[42:43], v6 offset:37376
    s_waitcnt lgkmcnt(10)
    v_mfma_f32_32x32x16_bf16 v[96:111], v[80:83], v[20:23], v[96:111]
    v_mfma_f32_32x32x16_bf16 v[112:127], v[84:87], v[20:23], v[112:127]
    s_waitcnt lgkmcnt(8)
    v_mfma_f32_32x32x16_bf16 v[48:63], v[24:27], v[128:131], 0
    ds_read_b64_tr_b16 v[44:45], v7 offset:36864
    ds_read_b64_tr_b16 v[46:47], v7 offset:37376
    s_nop 6
    v_mul_f32 v96, v16, v96
    v_mul_f32 v97, v16, v97
    v_mul_f32 v98, v16, v98
    v_mul_f32 v99, v16, v99
    v_mul_f32 v100, v16, v100
    s_waitcnt lgkmcnt(8)
    v_mfma_f32_32x32x16_bf16 v[64:79], v[28:31], v[128:131], 0
    ds_read_b64_tr_b16 v[24:25], v6 offset:38912
    ds_read_b64_tr_b16 v[26:27], v6 offset:39424
    v_mul_f32 v101, v16, v101
    v_mul_f32 v102, v16, v102
    v_mul_f32 v103, v16, v103
    v_cvt_pk_bf16_f32 v96, v96, v97
    v_cvt_pk_bf16_f32 v97, v98, v99
    s_waitcnt lgkmcnt(8)
    v_mfma_f32_32x32x16_bf16 v[48:63], v[32:35], v[132:135], v[48:63]
    ds_read_b64_tr_b16 v[28:29], v7 offset:38912
    ds_read_b64_tr_b16 v[30:31], v7 offset:39424
    v_cvt_pk_bf16_f32 v98, v100, v101
    v_cvt_pk_bf16_f32 v99, v102, v103
    v_pk_max_i16 v96, v96, 0
    v_pk_max_i16 v97, v97, 0
    v_pk_max_i16 v98, v98, 0
    s_waitcnt lgkmcnt(8)
    v_mfma_f32_32x32x16_bf16 v[64:79], v[36:39], v[132:135], v[64:79]
    ds_read_b64_tr_b16 v[32:33], v6 offset:40960
    ds_read_b64_tr_b16 v[34:35], v6 offset:41472
    v_pk_max_i16 v99, v99, 0
    s_add_u32 s79, s70, 0
    buffer_store_dwordx4 v[96:99], v13, s[48:51], s79 offen sc1
    v_mul_f32 v104, v16, v104
    v_mul_f32 v105, v16, v105
    s_waitcnt lgkmcnt(8)
    v_mfma_f32_32x32x16_bf16 v[48:63], v[40:43], v[136:139], v[48:63]
    ds_read_b64_tr_b16 v[36:37], v7 offset:40960
    ds_read_b64_tr_b16 v[38:39], v7 offset:41472
    v_mul_f32 v106, v16, v106
    v_mul_f32 v107, v16, v107
    v_mul_f32 v108, v16, v108
    v_mul_f32 v109, v16, v109
    v_mul_f32 v110, v16, v110
    s_waitcnt lgkmcnt(8)
    v_mfma_f32_32x32x16_bf16 v[64:79], v[44:47], v[136:139], v[64:79]
    ds_read_b64_tr_b16 v[40:41], v6 offset:43008
    ds_read_b64_tr_b16 v[42:43], v6 offset:43520
    v_mul_f32 v111, v16, v111
    v_cvt_pk_bf16_f32 v100, v104, v105
    v_cvt_pk_bf16_f32 v101, v106, v107
    v_cvt_pk_bf16_f32 v102, v108, v109
    v_cvt_pk_bf16_f32 v103, v110, v111
    s_waitcnt lgkmcnt(8)
    v_mfma_f32_32x32x16_bf16 v[48:63], v[24:27], v[140:143], v[48:63]
    ds_read_b64_tr_b16 v[44:45], v7 offset:43008
    ds_read_b64_tr_b16 v[46:47], v7 offset:43520
    v_pk_max_i16 v100, v100, 0
    v_pk_max_i16 v101, v101, 0
    v_pk_max_i16 v102, v102, 0
    v_pk_max_i16 v103, v103, 0
    s_add_u32 s79, s70, 1024
    s_waitcnt lgkmcnt(8)
    v_mfma_f32_32x32x16_bf16 v[64:79], v[28:31], v[140:143], v[64:79]
    ds_read_b64_tr_b16 v[24:25], v6 offset:45056
    ds_read_b64_tr_b16 v[26:27], v6 offset:45568
    buffer_store_dwordx4 v[100:103], v13, s[48:51], s79 offen sc1
    v_mul_f32 v112, v16, v112
    v_mul_f32 v113, v16, v113
    v_mul_f32 v114, v16, v114
    v_mul_f32 v115, v16, v115
    s_waitcnt lgkmcnt(8)
    v_mfma_f32_32x32x16_bf16 v[48:63], v[32:35], v[144:147], v[48:63]
    ds_read_b64_tr_b16 v[28:29], v7 offset:45056
    ds_read_b64_tr_b16 v[30:31], v7 offset:45568
    v_mul_f32 v116, v16, v116
    v_mul_f32 v117, v16, v117
    v_mul_f32 v118, v16, v118
    v_mul_f32 v119, v16, v119
    v_cvt_pk_bf16_f32 v112, v112, v113
    s_waitcnt lgkmcnt(8)
    v_mfma_f32_32x32x16_bf16 v[64:79], v[36:39], v[144:147], v[64:79]
    ds_read_b64_tr_b16 v[32:33], v6 offset:47104
    ds_read_b64_tr_b16 v[34:35], v6 offset:47616
    v_cvt_pk_bf16_f32 v113, v114, v115
    v_cvt_pk_bf16_f32 v114, v116, v117
    v_cvt_pk_bf16_f32 v115, v118, v119
    v_pk_max_i16 v112, v112, 0
    v_pk_max_i16 v113, v113, 0
    s_waitcnt lgkmcnt(8)
    v_mfma_f32_32x32x16_bf16 v[48:63], v[40:43], v[148:151], v[48:63]
    ds_read_b64_tr_b16 v[36:37], v7 offset:47104
    ds_read_b64_tr_b16 v[38:39], v7 offset:47616
    v_pk_max_i16 v114, v114, 0
    v_pk_max_i16 v115, v115, 0
    s_add_u32 s79, s70, 2048
    buffer_store_dwordx4 v[112:115], v13, s[48:51], s79 offen sc1
    v_mul_f32 v120, v16, v120
    s_waitcnt lgkmcnt(8)
    v_mfma_f32_32x32x16_bf16 v[64:79], v[44:47], v[148:151], v[64:79]
    ds_read_b64_tr_b16 v[40:41], v8 offset:32768
    ds_read_b64_tr_b16 v[42:43], v8 offset:33280
    v_mul_f32 v121, v16, v121
    v_mul_f32 v122, v16, v122
    v_mul_f32 v123, v16, v123
    v_mul_f32 v124, v16, v124
    v_mul_f32 v125, v16, v125
    s_waitcnt lgkmcnt(8)
    v_mfma_f32_32x32x16_bf16 v[48:63], v[24:27], v[152:155], v[48:63]
    ds_read_b64_tr_b16 v[44:45], v9 offset:32768
    ds_read_b64_tr_b16 v[46:47], v9 offset:33280
    v_mul_f32 v126, v16, v126
    v_mul_f32 v127, v16, v127
    v_cvt_pk_bf16_f32 v116, v120, v121
    v_cvt_pk_bf16_f32 v117, v122, v123
    v_cvt_pk_bf16_f32 v118, v124, v125
    s_waitcnt lgkmcnt(8)
    v_mfma_f32_32x32x16_bf16 v[64:79], v[28:31], v[152:155], v[64:79]
    ds_read_b64_tr_b16 v[24:25], v8 offset:34816
    ds_read_b64_tr_b16 v[26:27], v8 offset:35328
    v_cvt_pk_bf16_f32 v119, v126, v127
    v_pk_max_i16 v116, v116, 0
    v_pk_max_i16 v117, v117, 0
    v_pk_max_i16 v118, v118, 0
    v_pk_max_i16 v119, v119, 0
    s_waitcnt lgkmcnt(8)
    v_mfma_f32_32x32x16_bf16 v[48:63], v[32:35], v[156:159], v[48:63]
    ds_read_b64_tr_b16 v[28:29], v9 offset:34816
    ds_read_b64_tr_b16 v[30:31], v9 offset:35328
    s_add_u32 s79, s70, 3072
    buffer_store_dwordx4 v[116:119], v13, s[48:51], s79 offen sc1
    s_mov_b32 s77, 0
    s_waitcnt lgkmcnt(8)
    v_mfma_f32_32x32x16_bf16 v[64:79], v[36:39], v[156:159], v[64:79]
    ds_read_b64_tr_b16 v[32:33], v8 offset:36864
    ds_read_b64_tr_b16 v[34:35], v8 offset:37376
    s_waitcnt lgkmcnt(8)
    v_mfma_f32_32x32x16_bf16 v[48:63], v[40:43], v[160:163], v[48:63]
    ds_read_b64_tr_b16 v[36:37], v9 offset:36864
    ds_read_b64_tr_b16 v[38:39], v9 offset:37376
    s_waitcnt lgkmcnt(8)
    v_mfma_f32_32x32x16_bf16 v[64:79], v[44:47], v[160:163], v[64:79]
    ds_read_b64_tr_b16 v[40:41], v8 offset:38912
    ds_read_b64_tr_b16 v[42:43], v8 offset:39424
    s_waitcnt lgkmcnt(8)
    v_mfma_f32_32x32x16_bf16 v[48:63], v[24:27], v[164:167], v[48:63]
    ds_read_b64_tr_b16 v[44:45], v9 offset:38912
    ds_read_b64_tr_b16 v[46:47], v9 offset:39424
    s_getreg_b32 s64, hwreg(HW_REG_IB_STS)
    s_and_b32 s64, s64, 0xc0000f
    s_or_b32 s64, s64, s77
    s_cbranch_scc0 L_pub_258
L_pubr_259:
    s_waitcnt lgkmcnt(8)
    v_mfma_f32_32x32x16_bf16 v[64:79], v[28:31], v[164:167], v[64:79]
    ds_read_b64_tr_b16 v[24:25], v8 offset:40960
    ds_read_b64_tr_b16 v[26:27], v8 offset:41472
    s_waitcnt lgkmcnt(8)
    v_mfma_f32_32x32x16_bf16 v[48:63], v[32:35], v[168:171], v[48:63]
    ds_read_b64_tr_b16 v[28:29], v9 offset:40960
    ds_read_b64_tr_b16 v[30:31], v9 offset:41472
    s_waitcnt lgkmcnt(8)
    v_mfma_f32_32x32x16_bf16 v[64:79], v[36:39], v[168:171], v[64:79]
    ds_read_b64_tr_b16 v[32:33], v8 offset:43008
    ds_read_b64_tr_b16 v[34:35], v8 offset:43520
    s_waitcnt lgkmcnt(8)
    v_mfma_f32_32x32x16_bf16 v[48:63], v[40:43], v[172:175], v[48:63]
    ds_read_b64_tr_b16 v[36:37], v9 offset:43008
    ds_read_b64_tr_b16 v[38:39], v9 offset:43520
    s_waitcnt lgkmcnt(8)
    v_mfma_f32_32x32x16_bf16 v[64:79], v[44:47], v[172:175], v[64:79]
    ds_read_b64_tr_b16 v[40:41], v8 offset:45056
    ds_read_b64_tr_b16 v[42:43], v8 offset:45568
    s_getreg_b32 s64, hwreg(HW_REG_IB_STS)
    s_and_b32 s64, s64, 0xc0000f
    s_or_b32 s64, s64, s77
    s_cbranch_scc0 L_pub_260
L_pubr_261:
    s_waitcnt lgkmcnt(8)
    v_mfma_f32_32x32x16_bf16 v[48:63], v[24:27], v[176:179], v[48:63]
    ds_read_b64_tr_b16 v[44:45], v9 offset:45056
    ds_read_b64_tr_b16 v[46:47], v9 offset:45568
    s_waitcnt lgkmcnt(8)
    v_mfma_f32_32x32x16_bf16 v[64:79], v[28:31], v[176:179], v[64:79]
    ds_read_b64_tr_b16 v[24:25], v8 offset:47104
    ds_read_b64_tr_b16 v[26:27], v8 offset:47616
    s_waitcnt lgkmcnt(8)
    v_mfma_f32_32x32x16_bf16 v[48:63], v[32:35], v[180:183], v[48:63]
    ds_read_b64_tr_b16 v[28:29], v9 offset:47104
    ds_read_b64_tr_b16 v[30:31], v9 offset:47616
    s_mov_b64 exec, 1
    ds_add_u32 v90, v91 offset:12
    s_mov_b64 exec, -1
    s_mov_b32 s82, 0
L_s3b_256:
    ds_read_b32 v92, v90 offset:28
    s_add_u32 s82, s82, 1
    s_waitcnt lgkmcnt(0)
    v_readfirstlane_b32 s64, v92
    s_nop 0
    s_cmp_ge_u32 s64, 2
    s_cbranch_scc1 L_s3bd_257
    s_cmp_gt_u32 s82, 480000
    s_cbranch_scc1 L_s3bd_257
    s_sleep 2
    s_branch L_s3b_256
L_s3bd_257:
    s_waitcnt lgkmcnt(0)
    v_mfma_f32_32x32x16_bf16 v[64:79], v[36:39], v[180:183], v[64:79]
    ds_read_b64_tr_b16 v[32:33], v6 offset:0
    ds_read_b64_tr_b16 v[34:35], v6 offset:512
    s_waitcnt lgkmcnt(9)
    v_mfma_f32_32x32x16_bf16 v[48:63], v[40:43], v[184:187], v[48:63]
    ds_read_b64_tr_b16 v[36:37], v7 offset:0
    ds_read_b64_tr_b16 v[38:39], v7 offset:512
    s_getreg_b32 s64, hwreg(HW_REG_IB_STS)
    s_and_b32 s64, s64, 0xc0000f
    s_or_b32 s64, s64, s77
    s_cbranch_scc0 L_pub_262
L_pubr_263:
    s_waitcnt lgkmcnt(9)
    v_mfma_f32_32x32x16_bf16 v[64:79], v[44:47], v[184:187], v[64:79]
    ds_read_b64_tr_b16 v[40:41], v6 offset:2048
    ds_read_b64_tr_b16 v[42:43], v6 offset:2560
    s_waitcnt lgkmcnt(9)
    v_mfma_f32_32x32x16_bf16 v[48:63], v[24:27], v[188:191], v[48:63]
    ds_read_b64_tr_b16 v[44:45], v7 offset:2048
    ds_read_b64_tr_b16 v[46:47], v7 offset:2560
    s_waitcnt lgkmcnt(8)
    v_mfma_f32_32x32x16_bf16 v[64:79], v[28:31], v[188:191], v[64:79]
    ds_read_b64_tr_b16 v[24:25], v6 offset:4096
    ds_read_b64_tr_b16 v[26:27], v6 offset:4608
    s_waitcnt lgkmcnt(8)
    v_mfma_f32_32x32x16_bf16 v[48:63], v[32:35], v[192:195], v[48:63]
    ds_read_b64_tr_b16 v[28:29], v7 offset:4096
    ds_read_b64_tr_b16 v[30:31], v7 offset:4608
    s_waitcnt lgkmcnt(8)
    v_mfma_f32_32x32x16_bf16 v[64:79], v[36:39], v[192:195], v[64:79]
    ds_read_b64_tr_b16 v[32:33], v6 offset:6144
    ds_read_b64_tr_b16 v[34:35], v6 offset:6656
    s_getreg_b32 s64, hwreg(HW_REG_IB_STS)
    s_and_b32 s64, s64, 0xc0000f
    s_or_b32 s64, s64, s77
    s_cbranch_scc0 L_pub_264
L_pubr_265:
    s_waitcnt lgkmcnt(8)
    v_mfma_f32_32x32x16_bf16 v[48:63], v[40:43], v[196:199], v[48:63]
    ds_read_b64_tr_b16 v[36:37], v7 offset:6144
    ds_read_b64_tr_b16 v[38:39], v7 offset:6656
    s_waitcnt lgkmcnt(8)
    v_mfma_f32_32x32x16_bf16 v[64:79], v[44:47], v[196:199], v[64:79]
    ds_read_b64_tr_b16 v[40:41], v6 offset:8192
    ds_read_b64_tr_b16 v[42:43], v6 offset:8704
    s_waitcnt lgkmcnt(8)
    v_mfma_f32_32x32x16_bf16 v[48:63], v[24:27], v[200:203], v[48:63]
    ds_read_b64_tr_b16 v[44:45], v7 offset:8192
    ds_read_b64_tr_b16 v[46:47], v7 offset:8704
    s_waitcnt lgkmcnt(8)
    v_mfma_f32_32x32x16_bf16 v[64:79], v[28:31], v[200:203], v[64:79]
    ds_read_b64_tr_b16 v[24:25], v6 offset:10240
    ds_read_b64_tr_b16 v[26:27], v6 offset:10752
    s_waitcnt lgkmcnt(8)
    v_mfma_f32_32x32x16_bf16 v[48:63], v[32:35], v[204:207], v[48:63]
    ds_read_b64_tr_b16 v[28:29], v7 offset:10240
    ds_read_b64_tr_b16 v[30:31], v7 offset:10752
    s_getreg_b32 s64, hwreg(HW_REG_IB_STS)
    s_and_b32 s64, s64, 0xc0000f
    s_or_b32 s64, s64, s77
    s_cbranch_scc0 L_pub_266
L_pubr_267:
    s_waitcnt lgkmcnt(8)
    v_mfma_f32_32x32x16_bf16 v[64:79], v[36:39], v[204:207], v[64:79]
    ds_read_b64_tr_b16 v[32:33], v6 offset:12288
    ds_read_b64_tr_b16 v[34:35], v6 offset:12800
    s_waitcnt lgkmcnt(8)
    v_mfma_f32_32x32x16_bf16 v[48:63], v[40:43], v[208:211], v[48:63]
    ds_read_b64_tr_b16 v[36:37], v7 offset:12288
    ds_read_b64_tr_b16 v[38:39], v7 offset:12800
    s_waitcnt lgkmcnt(8)
    v_mfma_f32_32x32x16_bf16 v[64:79], v[44:47], v[208:211], v[64:79]
    ds_read_b64_tr_b16 v[40:41], v6 offset:14336
    ds_read_b64_tr_b16 v[42:43], v6 offset:14848
    s_waitcnt lgkmcnt(8)
    v_mfma_f32_32x32x16_bf16 v[48:63], v[24:27], v[212:215], v[48:63]
    ds_read_b64_tr_b16 v[44:45], v7 offset:14336
    ds_read_b64_tr_b16 v[46:47], v7 offset:14848
    s_waitcnt lgkmcnt(8)
    v_mfma_f32_32x32x16_bf16 v[64:79], v[28:31], v[212:215], v[64:79]
    ds_read_b64_tr_b16 v[24:25], v8 offset:0
    ds_read_b64_tr_b16 v[26:27], v8 offset:512
    s_getreg_b32 s64, hwreg(HW_REG_IB_STS)
    s_and_b32 s64, s64, 0xc0000f
    s_or_b32 s64, s64, s77
    s_cbranch_scc0 L_pub_268
L_pubr_269:
    s_waitcnt lgkmcnt(8)
    v_mfma_f32_32x32x16_bf16 v[48:63], v[32:35], v[216:219], v[48:63]
    ds_read_b64_tr_b16 v[28:29], v9 offset:0
    ds_read_b64_tr_b16 v[30:31], v9 offset:512
    s_waitcnt lgkmcnt(8)
    v_mfma_f32_32x32x16_bf16 v[64:79], v[36:39], v[216:219], v[64:79]
    ds_read_b64_tr_b16 v[32:33], v8 offset:2048
    ds_read_b64_tr_b16 v[34:35], v8 offset:2560
    s_waitcnt lgkmcnt(8)
    v_mfma_f32_32x32x16_bf16 v[48:63], v[40:43], v[220:223], v[48:63]
    ds_read_b64_tr_b16 v[36:37], v9 offset:2048
    ds_read_b64_tr_b16 v[38:39], v9 offset:2560
    s_waitcnt lgkmcnt(8)
    v_mfma_f32_32x32x16_bf16 v[64:79], v[44:47], v[220:223], v[64:79]
    ds_read_b64_tr_b16 v[40:41], v8 offset:4096
    ds_read_b64_tr_b16 v[42:43], v8 offset:4608
    s_waitcnt lgkmcnt(8)
    v_mfma_f32_32x32x16_bf16 v[48:63], v[24:27], v[224:227], v[48:63]
    ds_read_b64_tr_b16 v[44:45], v9 offset:4096
    ds_read_b64_tr_b16 v[46:47], v9 offset:4608
    s_getreg_b32 s64, hwreg(HW_REG_IB_STS)
    s_and_b32 s64, s64, 0xc0000f
    s_or_b32 s64, s64, s77
    s_cbranch_scc0 L_pub_270
L_pubr_271:
    s_waitcnt lgkmcnt(8)
    v_mfma_f32_32x32x16_bf16 v[64:79], v[28:31], v[224:227], v[64:79]
    ds_read_b64_tr_b16 v[24:25], v8 offset:6144
    ds_read_b64_tr_b16 v[26:27], v8 offset:6656
    s_waitcnt lgkmcnt(8)
    v_mfma_f32_32x32x16_bf16 v[48:63], v[32:35], v[228:231], v[48:63]
    ds_read_b64_tr_b16 v[28:29], v9 offset:6144
    ds_read_b64_tr_b16 v[30:31], v9 offset:6656
    s_waitcnt lgkmcnt(8)
    v_mfma_f32_32x32x16_bf16 v[64:79], v[36:39], v[228:231], v[64:79]
    ds_read_b64_tr_b16 v[32:33], v8 offset:8192
    ds_read_b64_tr_b16 v[34:35], v8 offset:8704
    s_waitcnt lgkmcnt(8)
    v_mfma_f32_32x32x16_bf16 v[48:63], v[40:43], v[232:235], v[48:63]
    ds_read_b64_tr_b16 v[36:37], v9 offset:8192
    ds_read_b64_tr_b16 v[38:39], v9 offset:8704
    s_waitcnt lgkmcnt(8)
    v_mfma_f32_32x32x16_bf16 v[64:79], v[44:47], v[232:235], v[64:79]
    ds_read_b64_tr_b16 v[40:41], v8 offset:10240
    ds_read_b64_tr_b16 v[42:43], v8 offset:10752
    s_getreg_b32 s64, hwreg(HW_REG_IB_STS)
    s_and_b32 s64, s64, 0xc0000f
    s_or_b32 s64, s64, s77
    s_cbranch_scc0 L_pub_272
L_pubr_273:
    s_waitcnt lgkmcnt(8)
    v_mfma_f32_32x32x16_bf16 v[48:63], v[24:27], v[236:239], v[48:63]
    ds_read_b64_tr_b16 v[44:45], v9 offset:10240
    ds_read_b64_tr_b16 v[46:47], v9 offset:10752
    s_waitcnt lgkmcnt(8)
    v_mfma_f32_32x32x16_bf16 v[64:79], v[28:31], v[236:239], v[64:79]
    ds_read_b64_tr_b16 v[24:25], v8 offset:12288
    ds_read_b64_tr_b16 v[26:27], v8 offset:12800
    s_waitcnt lgkmcnt(8)
    v_mfma_f32_32x32x16_bf16 v[48:63], v[32:35], v[240:243], v[48:63]
    ds_read_b64_tr_b16 v[28:29], v9 offset:12288
    ds_read_b64_tr_b16 v[30:31], v9 offset:12800
    s_waitcnt lgkmcnt(8)
    v_mfma_f32_32x32x16_bf16 v[64:79], v[36:39], v[240:243], v[64:79]
    ds_read_b64_tr_b16 v[32:33], v8 offset:14336
    ds_read_b64_tr_b16 v[34:35], v8 offset:14848
    s_waitcnt lgkmcnt(8)
    v_mfma_f32_32x32x16_bf16 v[48:63], v[40:43], v[244:247], v[48:63]
    ds_read_b64_tr_b16 v[36:37], v9 offset:14336
    ds_read_b64_tr_b16 v[38:39], v9 offset:14848
    s_getreg_b32 s64, hwreg(HW_REG_IB_STS)
    s_and_b32 s64, s64, 0xc0000f
    s_or_b32 s64, s64, s77
    s_cbranch_scc0 L_pub_274
L_pubr_275:
    s_waitcnt lgkmcnt(8)
    v_mfma_f32_32x32x16_bf16 v[64:79], v[44:47], v[244:247], v[64:79]
    s_waitcnt lgkmcnt(6)
    v_mfma_f32_32x32x16_bf16 v[48:63], v[24:27], v[248:251], v[48:63]
    s_waitcnt lgkmcnt(4)
    v_mfma_f32_32x32x16_bf16 v[64:79], v[28:31], v[248:251], v[64:79]
    s_cmp_eq_u32 s77, 0
    s_cbranch_scc1 L_pub_276
L_pubr_277:
    s_waitcnt lgkmcnt(2)
    v_mfma_f32_32x32x16_bf16 v[48:63], v[32:35], v[252:255], v[48:63]
    s_waitcnt lgkmcnt(0)
    v_mfma_f32_32x32x16_bf16 v[64:79], v[36:39], v[252:255], v[64:79]
    s_mov_b32 s73, 2
    s_branch L_fbj_255
L_fb1_254:
    ds_read_b64_tr_b16 v[24:25], v6 offset:32768
    ds_read_b64_tr_b16 v[26:27], v6 offset:33280
    ds_read_b64_tr_b16 v[28:29], v6 offset:34816
    ds_read_b64_tr_b16 v[30:31], v6 offset:35328
    ds_read_b64_tr_b16 v[32:33], v6 offset:36864
    ds_read_b64_tr_b16 v[34:35], v6 offset:37376
    ds_read_b64_tr_b16 v[36:37], v6 offset:38912
    ds_read_b64_tr_b16 v[38:39], v6 offset:39424
    ds_read_b64_tr_b16 v[40:41], v6 offset:40960
    ds_read_b64_tr_b16 v[42:43], v6 offset:41472
    s_waitcnt lgkmcnt(10)
    v_mfma_f32_32x32x16_bf16 v[96:111], v[80:83], v[20:23], v[96:111]
    v_mfma_f32_32x32x16_bf16 v[112:127], v[84:87], v[20:23], v[112:127]
    s_waitcnt lgkmcnt(8)
    v_mfma_f32_32x32x16_bf16 v[48:63], v[24:27], v[128:131], 0
    ds_read_b64_tr_b16 v[44:45], v6 offset:43008
    ds_read_b64_tr_b16 v[46:47], v6 offset:43520
    s_nop 6
    v_mul_f32 v96, v16, v96
    v_mul_f32 v97, v16, v97
    v_mul_f32 v98, v16, v98
    v_mul_f32 v99, v16, v99
    v_mul_f32 v100, v16, v100
    v_mul_f32 v101, v16, v101
    s_waitcnt lgkmcnt(8)
    v_mfma_f32_32x32x16_bf16 v[48:63], v[28:31], v[132:135], v[48:63]
    ds_read_b64_tr_b16 v[24:25], v6 offset:45056
    ds_read_b64_tr_b16 v[26:27], v6 offset:45568
    v_mul_f32 v102, v16, v102
    v_mul_f32 v103, v16, v103
    v_cvt_pk_bf16_f32 v96, v96, v97
    v_cvt_pk_bf16_f32 v97, v98, v99
    v_cvt_pk_bf16_f32 v98, v100, v101
    v_cvt_pk_bf16_f32 v99, v102, v103
    s_waitcnt lgkmcnt(8)
    v_mfma_f32_32x32x16_bf16 v[48:63], v[32:35], v[136:139], v[48:63]
    ds_read_b64_tr_b16 v[28:29], v6 offset:47104
    ds_read_b64_tr_b16 v[30:31], v6 offset:47616
    v_pk_max_i16 v96, v96, 0
    v_pk_max_i16 v97, v97, 0
    v_pk_max_i16 v98, v98, 0
    v_pk_max_i16 v99, v99, 0
    s_add_u32 s79, s70, 0
    buffer_store_dwordx4 v[96:99], v13, s[48:51], s79 offen sc1
    s_waitcnt lgkmcnt(8)
    v_mfma_f32_32x32x16_bf16 v[48:63], v[36:39], v[140:143], v[48:63]
    ds_read_b64_tr_b16 v[32:33], v8 offset:32768
    ds_read_b64_tr_b16 v[34:35], v8 offset:33280
    v_mul_f32 v104, v16, v104
    v_mul_f32 v105, v16, v105
    v_mul_f32 v106, v16, v106
    v_mul_f32 v107, v16, v107
    v_mul_f32 v108, v16, v108
    v_mul_f32 v109, v16, v109
    s_waitcnt lgkmcnt(8)
    v_mfma_f32_32x32x16_bf16 v[48:63], v[40:43], v[144:147], v[48:63]
    ds_read_b64_tr_b16 v[36:37], v8 offset:34816
    ds_read_b64_tr_b16 v[38:39], v8 offset:35328
    v_mul_f32 v110, v16, v110
    v_mul_f32 v111, v16, v111
    v_cvt_pk_bf16_f32 v100, v104, v105
    v_cvt_pk_bf16_f32 v101, v106, v107
    v_cvt_pk_bf16_f32 v102, v108, v109
    v_cvt_pk_bf16_f32 v103, v110, v111
    s_waitcnt lgkmcnt(8)
    v_mfma_f32_32x32x16_bf16 v[48:63], v[44:47], v[148:151], v[48:63]
    ds_read_b64_tr_b16 v[40:41], v8 offset:36864
    ds_read_b64_tr_b16 v[42:43], v8 offset:37376
    v_pk_max_i16 v100, v100, 0
    v_pk_max_i16 v101, v101, 0
    v_pk_max_i16 v102, v102, 0
    v_pk_max_i16 v103, v103, 0
    s_add_u32 s79, s70, 1024
    buffer_store_dwordx4 v[100:103], v13, s[48:51], s79 offen sc1
    s_waitcnt lgkmcnt(8)
    v_mfma_f32_32x32x16_bf16 v[48:63], v[24:27], v[152:155], v[48:63]
    ds_read_b64_tr_b16 v[44:45], v8 offset:38912
    ds_read_b64_tr_b16 v[46:47], v8 offset:39424
    v_mul_f32 v112, v16, v112
    v_mul_f32 v113, v16, v113
    v_mul_f32 v114, v16, v114
    v_mul_f32 v115, v16, v115
    v_mul_f32 v116, v16, v116
    v_mul_f32 v117, v16, v117
    s_waitcnt lgkmcnt(8)
    v_mfma_f32_32x32x16_bf16 v[48:63], v[28:31], v[156:159], v[48:63]
    ds_read_b64_tr_b16 v[24:25], v8 offset:40960
    ds_read_b64_tr_b16 v[26:27], v8 offset:41472
    v_mul_f32 v118, v16, v118
    v_mul_f32 v119, v16, v119
    v_cvt_pk_bf16_f32 v112, v112, v113
    v_cvt_pk_bf16_f32 v113, v114, v115
    v_cvt_pk_bf16_f32 v114, v116, v117
    v_cvt_pk_bf16_f32 v115, v118, v119
    s_waitcnt lgkmcnt(8)
    v_mfma_f32_32x32x16_bf16 v[48:63], v[32:35], v[160:163], v[48:63]
    ds_read_b64_tr_b16 v[28:29], v8 offset:43008
    ds_read_b64_tr_b16 v[30:31], v8 offset:43520
    v_pk_max_i16 v112, v112, 0
    v_pk_max_i16 v113, v113, 0
    v_pk_max_i16 v114, v114, 0
    v_pk_max_i16 v115, v115, 0
    s_add_u32 s79, s70, 2048
    buffer_store_dwordx4 v[112:115], v13, s[48:51], s79 offen sc1
    s_waitcnt lgkmcnt(8)
    v_mfma_f32_32x32x16_bf16 v[48:63], v[36:39], v[164:167], v[48:63]
    ds_read_b64_tr_b16 v[32:33], v8 offset:45056
    ds_read_b64_tr_b16 v[34:35], v8 offset:45568
    v_mul_f32 v120, v16, v120
    v_mul_f32 v121, v16, v121
    v_mul_f32 v122, v16, v122
    v_mul_f32 v123, v16, v123
    v_mul_f32 v124, v16, v124
    v_mul_f32 v125, v16, v125
    s_waitcnt lgkmcnt(8)
    v_mfma_f32_32x32x16_bf16 v[48:63], v[40:43], v[168:171], v[48:63]
    ds_read_b64_tr_b16 v[36:37], v8 offset:47104
    ds_read_b64_tr_b16 v[38:39], v8 offset:47616
    s_mov_b64 exec, 1
    ds_add_u32 v90, v91 offset:12
    s_mov_b64 exec, -1
    v_mul_f32 v126, v16, v126
    v_mul_f32 v127, v16, v127
    v_cvt_pk_bf16_f32 v116, v120, v121
    v_cvt_pk_bf16_f32 v117, v122, v123
    v_cvt_pk_bf16_f32 v118, v124, v125
    v_cvt_pk_bf16_f32 v119, v126, v127
    s_mov_b32 s82, 0
L_s3b_278:
    ds_read_b32 v92, v90 offset:28
    s_add_u32 s82, s82, 1
    s_waitcnt lgkmcnt(0)
    v_readfirstlane_b32 s64, v92
    s_nop 0
    s_cmp_ge_u32 s64, 2
    s_cbranch_scc1 L_s3bd_279
    s_cmp_gt_u32 s82, 480000
    s_cbranch_scc1 L_s3bd_279
    s_sleep 2
    s_branch L_s3b_278
L_s3bd_279:
    s_waitcnt lgkmcnt(0)
    v_mfma_f32_32x32x16_bf16 v[48:63], v[44:47], v[172:175], v[48:63]
    ds_read_b64_tr_b16 v[40:41], v6 offset:0
    ds_read_b64_tr_b16 v[42:43], v6 offset:512
    v_pk_max_i16 v116, v116, 0
    v_pk_max_i16 v117, v117, 0
    v_pk_max_i16 v118, v118, 0
    v_pk_max_i16 v119, v119, 0
    s_add_u32 s79, s70, 3072
    buffer_store_dwordx4 v[116:119], v13, s[48:51], s79 offen sc1
    s_waitcnt lgkmcnt(9)
    v_mfma_f32_32x32x16_bf16 v[48:63], v[24:27], v[176:179], v[48:63]
    ds_read_b64_tr_b16 v[44:45], v6 offset:2048
    ds_read_b64_tr_b16 v[46:47], v6 offset:2560
    s_mov_b32 s77, 0
    s_waitcnt lgkmcnt(9)
    v_mfma_f32_32x32x16_bf16 v[48:63], v[28:31], v[180:183], v[48:63]
    ds_read_b64_tr_b16 v[24:25], v6 offset:4096
    ds_read_b64_tr_b16 v[26:27], v6 offset:4608
    s_waitcnt lgkmcnt(9)
    v_mfma_f32_32x32x16_bf16 v[48:63], v[32:35], v[184:187], v[48:63]
    ds_read_b64_tr_b16 v[28:29], v6 offset:6144
    ds_read_b64_tr_b16 v[30:31], v6 offset:6656
    s_waitcnt lgkmcnt(8)
    v_mfma_f32_32x32x16_bf16 v[48:63], v[36:39], v[188:191], v[48:63]
    ds_read_b64_tr_b16 v[32:33], v6 offset:8192
    ds_read_b64_tr_b16 v[34:35], v6 offset:8704
    s_waitcnt lgkmcnt(8)
    v_mfma_f32_32x32x16_bf16 v[48:63], v[40:43], v[192:195], v[48:63]
    ds_read_b64_tr_b16 v[36:37], v6 offset:10240
    ds_read_b64_tr_b16 v[38:39], v6 offset:10752
    s_getreg_b32 s64, hwreg(HW_REG_IB_STS)
    s_and_b32 s64, s64, 0xc0000f
    s_or_b32 s64, s64, s77
    s_cbranch_scc0 L_pub_280
L_pubr_281:
    s_waitcnt lgkmcnt(8)
    v_mfma_f32_32x32x16_bf16 v[48:63], v[44:47], v[196:199], v[48:63]
    ds_read_b64_tr_b16 v[40:41], v6 offset:12288
    ds_read_b64_tr_b16 v[42:43], v6 offset:12800
    s_waitcnt lgkmcnt(8)
    v_mfma_f32_32x32x16_bf16 v[48:63], v[24:27], v[200:203], v[48:63]
    ds_read_b64_tr_b16 v[44:45], v6 offset:14336
    ds_read_b64_tr_b16 v[46:47], v6 offset:14848
    s_waitcnt lgkmcnt(8)
    v_mfma_f32_32x32x16_bf16 v[48:63], v[28:31], v[204:207], v[48:63]
    ds_read_b64_tr_b16 v[24:25], v8 offset:0
    ds_read_b64_tr_b16 v[26:27], v8 offset:512
    s_getreg_b32 s64, hwreg(HW_REG_IB_STS)
    s_and_b32 s64, s64, 0xc0000f
    s_or_b32 s64, s64, s77
    s_cbranch_scc0 L_pub_282
L_pubr_283:
    s_waitcnt lgkmcnt(8)
    v_mfma_f32_32x32x16_bf16 v[48:63], v[32:35], v[208:211], v[48:63]
    ds_read_b64_tr_b16 v[28:29], v8 offset:2048
    ds_read_b64_tr_b16 v[30:31], v8 offset:2560
    s_waitcnt lgkmcnt(8)
    v_mfma_f32_32x32x16_bf16 v[48:63], v[36:39], v[212:215], v[48:63]
    ds_read_b64_tr_b16 v[32:33], v8 offset:4096
    ds_read_b64_tr_b16 v[34:35], v8 offset:4608
    s_waitcnt lgkmcnt(8)
    v_mfma_f32_32x32x16_bf16 v[48:63], v[40:43], v[216:219], v[48:63]
    ds_read_b64_tr_b16 v[36:37], v8 offset:6144
    ds_read_b64_tr_b16 v[38:39], v8 offset:6656
    s_getreg_b32 s64, hwreg(HW_REG_IB_STS)
    s_and_b32 s64, s64, 0xc0000f
    s_or_b32 s64, s64, s77
    s_cbranch_scc0 L_pub_284
L_pubr_285:
    s_waitcnt lgkmcnt(8)
    v_mfma_f32_32x32x16_bf16 v[48:63], v[44:47], v[220:223], v[48:63]
    ds_read_b64_tr_b16 v[40:41], v8 offset:8192
    ds_read_b64_tr_b16 v[42:43], v8 offset:8704
    s_waitcnt lgkmcnt(8)
    v_mfma_f32_32x32x16_bf16 v[48:63], v[24:27], v[224:227], v[48:63]
    ds_read_b64_tr_b16 v[44:45], v8 offset:10240
    ds_read_b64_tr_b16 v[46:47], v8 offset:10752
    s_waitcnt lgkmcnt(8)
    v_mfma_f32_32x32x16_bf16 v[48:63], v[28:31], v[228:231], v[48:63]
    ds_read_b64_tr_b16 v[24:25], v8 offset:12288
    ds_read_b64_tr_b16 v[26:27], v8 offset:12800
    s_getreg_b32 s64, hwreg(HW_REG_IB_STS)
    s_and_b32 s64, s64, 0xc0000f
    s_or_b32 s64, s64, s77
    s_cbranch_scc0 L_pub_286
L_pubr_287:
    s_waitcnt lgkmcnt(8)
    v_mfma_f32_32x32x16_bf16 v[48:63], v[32:35], v[232:235], v[48:63]
    ds_read_b64_tr_b16 v[28:29], v8 offset:14336
    ds_read_b64_tr_b16 v[30:31], v8 offset:14848
    s_waitcnt lgkmcnt(8)
    v_mfma_f32_32x32x16_bf16 v[48:63], v[36:39], v[236:239], v[48:63]
    s_waitcnt lgkmcnt(6)
    v_mfma_f32_32x32x16_bf16 v[48:63], v[40:43], v[240:243], v[48:63]
    s_getreg_b32 s64, hwreg(HW_REG_IB_STS)
    s_and_b32 s64, s64, 0xc0000f
    s_or_b32 s64, s64, s77
    s_cbranch_scc0 L_pub_288
L_pubr_289:
    s_waitcnt lgkmcnt(4)
    v_mfma_f32_32x32x16_bf16 v[48:63], v[44:47], v[244:247], v[48:63]
    s_cmp_eq_u32 s77, 0
    s_cbranch_scc1 L_pub_290
L_pubr_291:
    s_waitcnt lgkmcnt(2)
    v_mfma_f32_32x32x16_bf16 v[48:63], v[24:27], v[248:251], v[48:63]
    s_waitcnt lgkmcnt(0)
    v_mfma_f32_32x32x16_bf16 v[48:63], v[28:31], v[252:255], v[48:63]
    s_mov_b32 s73, 1
    s_lshl_b32 s64, s76, 1
    v_add_u32 v11, s64, v11
L_fbj_255:
    s_mul_i32 s66, s62, 28672
    s_add_u32 s66, s66, s29
    s_lshl_b32 s67, s62, 13
    s_add_u32 s67, s67, s29
    s_add_u32 s67, s67, 114688
    s_add_u32 s78, s72, 524288
    s_lshl_b32 s64, s60, 13
    s_lshl_b32 s65, s62, 9
    s_add_u32 s64, s64, s65
    s_add_u32 s64, s64, 15990784
    s_add_u32 s20, s20, s64
    s_addc_u32 s21, s21, 0
    ds_read_b32 v80, v11 offset:768
    ds_read_b32 v84, v11 offset:896
    s_waitcnt lgkmcnt(0)
    v_mfma_f32_32x32x16_bf16 v[48:63], v[80:83], v[20:23], v[48:63]
    v_mfma_f32_32x32x16_bf16 v[64:79], v[84:87], v[20:23], v[64:79]
    s_setprio 0
    s_nop 8
    s_nop 0
    v_mul_f32 v48, v16, v48
    v_mul_f32 v49, v16, v49
    v_mul_f32 v50, v16, v50
    v_mul_f32 v51, v16, v51
    v_mul_f32 v52, v16, v52
    v_mul_f32 v53, v16, v53
    v_mul_f32 v54, v16, v54
    v_mul_f32 v55, v16, v55
    v_cvt_pk_bf16_f32 v48, v48, v49
    v_cvt_pk_bf16_f32 v49, v50, v51
    v_cvt_pk_bf16_f32 v50, v52, v53
    v_cvt_pk_bf16_f32 v51, v54, v55
    v_pk_max_i16 v48, v48, 0
    v_pk_max_i16 v49, v49, 0
    v_pk_max_i16 v50, v50, 0
    v_pk_max_i16 v51, v51, 0
    v_mul_f32 v56, v16, v56
    v_mul_f32 v57, v16, v57
    v_mul_f32 v58, v16, v58
    v_mul_f32 v59, v16, v59
    v_mul_f32 v60, v16, v60
    v_mul_f32 v61, v16, v61
    v_mul_f32 v62, v16, v62
    v_mul_f32 v63, v16, v63
    v_cvt_pk_bf16_f32 v52, v56, v57
    v_cvt_pk_bf16_f32 v53, v58, v59
    v_cvt_pk_bf16_f32 v54, v60, v61
    v_cvt_pk_bf16_f32 v55, v62, v63
    v_pk_max_i16 v52, v52, 0
    v_pk_max_i16 v53, v53, 0
    v_pk_max_i16 v54, v54, 0
    v_pk_max_i16 v55, v55, 0
    v_mul_f32 v64, v16, v64
    v_mul_f32 v65, v16, v65
    v_mul_f32 v66, v16, v66
    v_mul_f32 v67, v16, v67
    v_mul_f32 v68, v16, v68
    v_mul_f32 v69, v16, v69
    v_mul_f32 v70, v16, v70
    v_mul_f32 v71, v16, v71
    v_cvt_pk_bf16_f32 v64, v64, v65
    v_cvt_pk_bf16_f32 v65, v66, v67
    v_cvt_pk_bf16_f32 v66, v68, v69
    v_cvt_pk_bf16_f32 v67, v70, v71
    v_pk_max_i16 v64, v64, 0
    v_pk_max_i16 v65, v65, 0
    v_pk_max_i16 v66, v66, 0
    v_pk_max_i16 v67, v67, 0
    v_mul_f32 v72, v16, v72
    v_mul_f32 v73, v16, v73
    v_mul_f32 v74, v16, v74
    v_mul_f32 v75, v16, v75
    v_mul_f32 v76, v16, v76
    v_mul_f32 v77, v16, v77
    v_mul_f32 v78, v16, v78
    v_mul_f32 v79, v16, v79
    v_cvt_pk_bf16_f32 v68, v72, v73
    v_cvt_pk_bf16_f32 v69, v74, v75
    v_cvt_pk_bf16_f32 v70, v76, v77
    v_cvt_pk_bf16_f32 v71, v78, v79
    v_pk_max_i16 v68, v68, 0
    v_pk_max_i16 v69, v69, 0
    v_pk_max_i16 v70, v70, 0
    v_pk_max_i16 v71, v71, 0
    s_mov_b32 s69, s77
    s_load_dword s4, s[20:21], 0 glc
    s_load_dword s5, s[20:21], 128 glc
    s_load_dword s6, s[20:21], 256 glc
    s_load_dword s7, s[20:21], 384 glc
    s_load_dword s8, s[20:21], 4096 glc
    s_load_dword s9, s[20:21], 4224 glc
    s_load_dword s10, s[20:21], 4352 glc
    s_load_dword s11, s[20:21], 4480 glc
    s_add_u32 s79, s71, 0
    buffer_store_dwordx4 v[48:51], v13, s[48:51], s79 offen sc1
    s_add_u32 s79, s71, 1024
    buffer_store_dwordx4 v[52:55], v13, s[48:51], s79 offen sc1
    s_cmp_eq_u32 s73, 1
    s_cbranch_scc1 L_one_292
    s_add_u32 s79, s71, 2048
    buffer_store_dwordx4 v[64:67], v13, s[48:51], s79 offen sc1
    s_add_u32 s79, s71, 3072
    buffer_store_dwordx4 v[68:71], v13, s[48:51], s79 offen sc1
L_one_292:
    s_waitcnt lgkmcnt(0)
    s_xor_b32 s4, s4, s80
    s_xor_b32 s5, s5, s80
    s_or_b32 s4, s4, s5
    s_xor_b32 s6, s6, s80
    s_or_b32 s4, s4, s6
    s_xor_b32 s7, s7, s80
    s_or_b32 s4, s4, s7
    s_xor_b32 s8, s8, s80
    s_or_b32 s4, s4, s8
    s_xor_b32 s9, s9, s80
    s_or_b32 s4, s4, s9
    s_xor_b32 s10, s10, s80
    s_or_b32 s4, s4, s10
    s_xor_b32 s11, s11, s80
    s_or_b32 s4, s4, s11
    s_cbranch_scc1 L_hasl_293
L_haok_294:
    s_add_u32 s75, s63, 0
    s_and_b32 s75, s75, 15
    s_lshr_b32 s64, s75, 2
    s_min_u32 s64, s64, 2
    s_lshl2_add_u32 s75, s64, s75
    s_lshl_b32 s76, s75, 10
    s_add_u32 s76, s76, s66
    s_lshl_b32 s77, s75, 14
    s_add_u32 s77, s77, s22
    buffer_load_dwordx4 v[128:131], v13, s[48:51], s76 offen sc1
    buffer_load_dwordx4 v[132:135], v17, s[48:51], s76 offen sc1
    s_add_u32 s75, s63, 1
    s_and_b32 s75, s75, 15
    s_lshr_b32 s64, s75, 2
    s_min_u32 s64, s64, 2
    s_lshl2_add_u32 s75, s64, s75
    s_lshl_b32 s76, s75, 10
    s_add_u32 s76, s76, s66
    s_lshl_b32 s77, s75, 14
    s_add_u32 s77, s77, s22
    buffer_load_dwordx4 v[136:139], v13, s[48:51], s76 offen sc1
    buffer_load_dwordx4 v[140:143], v17, s[48:51], s76 offen sc1
    s_add_u32 s75, s63, 2
    s_and_b32 s75, s75, 15
    s_lshr_b32 s64, s75, 2
    s_min_u32 s64, s64, 2
    s_lshl2_add_u32 s75, s64, s75
    s_lshl_b32 s76, s75, 10
    s_add_u32 s76, s76, s66
    s_lshl_b32 s77, s75, 14
    s_add_u32 s77, s77, s22
    buffer_load_dwordx4 v[144:147], v13, s[48:51], s76 offen sc1
    buffer_load_dwordx4 v[148:151], v17, s[48:51], s76 offen sc1
    s_add_u32 s75, s63, 3
    s_and_b32 s75, s75, 15
    s_lshr_b32 s64, s75, 2
    s_min_u32 s64, s64, 2
    s_lshl2_add_u32 s75, s64, s75
    s_lshl_b32 s76, s75, 10
    s_add_u32 s76, s76, s66
    s_lshl_b32 s77, s75, 14
    s_add_u32 s77, s77, s22
    buffer_load_dwordx4 v[152:155], v13, s[48:51], s76 offen sc1
    buffer_load_dwordx4 v[156:159], v17, s[48:51], s76 offen sc1
    s_add_u32 s75, s63, 4
    s_and_b32 s75, s75, 15
    s_lshr_b32 s64, s75, 2
    s_min_u32 s64, s64, 2
    s_lshl2_add_u32 s75, s64, s75
    s_lshl_b32 s76, s75, 10
    s_add_u32 s76, s76, s66
    s_lshl_b32 s77, s75, 14
    s_add_u32 s77, s77, s22
    buffer_load_dwordx4 v[160:163], v13, s[48:51], s76 offen sc1
    buffer_load_dwordx4 v[164:167], v17, s[48:51], s76 offen sc1
    s_add_u32 s75, s63, 5
    s_and_b32 s75, s75, 15
    s_lshr_b32 s64, s75, 2
    s_min_u32 s64, s64, 2
    s_lshl2_add_u32 s75, s64, s75
    s_lshl_b32 s76, s75, 10
    s_add_u32 s76, s76, s66
    s_lshl_b32 s77, s75, 14
    s_add_u32 s77, s77, s22
    buffer_load_dwordx4 v[168:171], v13, s[48:51], s76 offen sc1
    buffer_load_dwordx4 v[172:175], v17, s[48:51], s76 offen sc1
    s_add_u32 s75, s63, 6
    s_and_b32 s75, s75, 15
    s_lshr_b32 s64, s75, 2
    s_min_u32 s64, s64, 2
    s_lshl2_add_u32 s75, s64, s75
    s_lshl_b32 s76, s75, 10
    s_add_u32 s76, s76, s66
    s_lshl_b32 s77, s75, 14
    s_add_u32 s77, s77, s22
    buffer_load_dwordx4 v[176:179], v13, s[48:51], s76 offen sc1
    buffer_load_dwordx4 v[180:183], v17, s[48:51], s76 offen sc1
    s_add_u32 s75, s63, 7
    s_and_b32 s75, s75, 15
    s_lshr_b32 s64, s75, 2
    s_min_u32 s64, s64, 2
    s_lshl2_add_u32 s75, s64, s75
    s_lshl_b32 s76, s75, 10
    s_add_u32 s76, s76, s66
    s_lshl_b32 s77, s75, 14
    s_add_u32 s77, s77, s22
    buffer_load_dwordx4 v[184:187], v13, s[48:51], s76 offen sc1
    buffer_load_dwordx4 v[188:191], v17, s[48:51], s76 offen sc1
    s_waitcnt vmcnt(16)
    v_mov_b32 v18, s80
    v_mov_b32 v19, s81
    s_mov_b64 exec, 1
    buffer_store_dwordx2 v[18:19], v15, s[48:51], s78 offen sc1
    s_mov_b64 exec, -1
    s_mov_b32 s82, 0
L_w2_297:
    ds_read_b32 v92, v90 offset:8
    s_add_u32 s82, s82, 1
    s_waitcnt lgkmcnt(0)
    v_readfirstlane_b32 s64, v92
    s_nop 0
    s_cmp_ge_u32 s64, 2
    s_cbranch_scc1 L_w2d_298
    s_cmp_gt_u32 s82, 480000
    s_cbranch_scc1 L_w2d_298
    s_sleep 2
    s_branch L_w2_297
L_w2d_298:
    ds_read_b64_tr_b16 v[24:25], v3 offset:0
    ds_read_b64_tr_b16 v[26:27], v3 offset:512
    ds_read_b64_tr_b16 v[28:29], v4 offset:0
    ds_read_b64_tr_b16 v[30:31], v4 offset:512
    s_waitcnt vmcnt(15)
    ds_read_b64_tr_b16 v[32:33], v3 offset:2048
    ds_read_b64_tr_b16 v[34:35], v3 offset:2560
    ds_read_b64_tr_b16 v[36:37], v4 offset:2048
    ds_read_b64_tr_b16 v[38:39], v4 offset:2560
    s_waitcnt lgkmcnt(4)
    s_add_u32 s75, s63, 8
    s_and_b32 s75, s75, 15
    s_lshr_b32 s64, s75, 2
    s_min_u32 s64, s64, 2
    s_lshl2_add_u32 s75, s64, s75
    s_lshl_b32 s76, s75, 10
    s_add_u32 s76, s76, s66
    s_lshl_b32 s77, s75, 14
    s_add_u32 s77, s77, s22
    v_mfma_f32_32x32x16_bf16 v[48:63], v[24:27], v[128:131], 0
    v_mfma_f32_32x32x16_bf16 v[64:79], v[24:27], v[132:135], 0
    v_mfma_f32_32x32x16_bf16 v[96:111], v[28:31], v[128:131], 0
    v_mfma_f32_32x32x16_bf16 v[112:127], v[28:31], v[132:135], 0
    s_add_u32 m0, s28, 0
    s_add_u32 s79, s77, 0
    buffer_load_dwordx4 v2, s[36:39], s79 offen   lds
    s_add_u32 s79, s77, 7168
    buffer_load_dwordx4 v2, s[36:39], s79 offen offset:1024  lds
    buffer_load_dwordx4 v[128:131], v13, s[48:51], s76 offen sc1
    buffer_load_dwordx4 v[132:135], v17, s[48:51], s76 offen sc1
    s_waitcnt vmcnt(17)
    ds_read_b64_tr_b16 v[24:25], v3 offset:4096
    ds_read_b64_tr_b16 v[26:27], v3 offset:4608
    ds_read_b64_tr_b16 v[28:29], v4 offset:4096
    ds_read_b64_tr_b16 v[30:31], v4 offset:4608
    s_waitcnt lgkmcnt(4)
    s_add_u32 s75, s63, 9
    s_and_b32 s75, s75, 15
    s_lshr_b32 s64, s75, 2
    s_min_u32 s64, s64, 2
    s_lshl2_add_u32 s75, s64, s75
    s_lshl_b32 s76, s75, 10
    s_add_u32 s76, s76, s66
    s_lshl_b32 s77, s75, 14
    s_add_u32 s77, s77, s22
    v_mfma_f32_32x32x16_bf16 v[48:63], v[32:35], v[136:139], v[48:63]
    v_mfma_f32_32x32x16_bf16 v[64:79], v[32:35], v[140:143], v[64:79]
    v_mfma_f32_32x32x16_bf16 v[96:111], v[36:39], v[136:139], v[96:111]
    v_mfma_f32_32x32x16_bf16 v[112:127], v[36:39], v[140:143], v[112:127]
    s_add_u32 m0, s28, 2048
    s_add_u32 s79, s77, 0
    buffer_load_dwordx4 v2, s[36:39], s79 offen   lds
    s_add_u32 s79, s77, 7168
    buffer_load_dwordx4 v2, s[36:39], s79 offen offset:1024  lds
    buffer_load_dwordx4 v[136:139], v13, s[48:51], s76 offen sc1
    buffer_load_dwordx4 v[140:143], v17, s[48:51], s76 offen sc1
    s_waitcnt vmcnt(19)
    ds_read_b64_tr_b16 v[32:33], v3 offset:6144
    ds_read_b64_tr_b16 v[34:35], v3 offset:6656
    ds_read_b64_tr_b16 v[36:37], v4 offset:6144
    ds_read_b64_tr_b16 v[38:39], v4 offset:6656
    s_waitcnt lgkmcnt(4)
    s_add_u32 s75, s63, 10
    s_and_b32 s75, s75, 15
    s_lshr_b32 s64, s75, 2
    s_min_u32 s64, s64, 2
    s_lshl2_add_u32 s75, s64, s75
    s_lshl_b32 s76, s75, 10
    s_add_u32 s76, s76, s66
    s_lshl_b32 s77, s75, 14
    s_add_u32 s77, s77, s22
    v_mfma_f32_32x32x16_bf16 v[48:63], v[24:27], v[144:147], v[48:63]
    v_mfma_f32_32x32x16_bf16 v[64:79], v[24:27], v[148:151], v[64:79]
    v_mfma_f32_32x32x16_bf16 v[96:111], v[28:31], v[144:147], v[96:111]
    v_mfma_f32_32x32x16_bf16 v[112:127], v[28:31], v[148:151], v[112:127]
    s_add_u32 m0, s28, 4096
    s_add_u32 s79, s77, 0
    buffer_load_dwordx4 v2, s[36:39], s79 offen   lds
    s_add_u32 s79, s77, 7168
    buffer_load_dwordx4 v2, s[36:39], s79 offen offset:1024  lds
    buffer_load_dwordx4 v[144:147], v13, s[48:51], s76 offen sc1
    buffer_load_dwordx4 v[148:151], v17, s[48:51], s76 offen sc1
    s_waitcnt vmcnt(21)
    ds_read_b64_tr_b16 v[24:25], v3 offset:8192
    ds_read_b64_tr_b16 v[26:27], v3 offset:8704
    ds_read_b64_tr_b16 v[28:29], v4 offset:8192
    ds_read_b64_tr_b16 v[30:31], v4 offset:8704
    s_waitcnt lgkmcnt(4)
    s_add_u32 s75, s63, 11
    s_and_b32 s75, s75, 15
    s_lshr_b32 s64, s75, 2
    s_min_u32 s64, s64, 2
    s_lshl2_add_u32 s75, s64, s75
    s_lshl_b32 s76, s75, 10
    s_add_u32 s76, s76, s66
    s_lshl_b32 s77, s75, 14
    s_add_u32 s77, s77, s22
    v_mfma_f32_32x32x16_bf16 v[48:63], v[32:35], v[152:155], v[48:63]
    v_mfma_f32_32x32x16_bf16 v[64:79], v[32:35], v[156:159], v[64:79]
    v_mfma_f32_32x32x16_bf16 v[96:111], v[36:39], v[152:155], v[96:111]
    v_mfma_f32_32x32x16_bf16 v[112:127], v[36:39], v[156:159], v[112:127]
    s_add_u32 m0, s28, 6144
    s_add_u32 s79, s77, 0
    buffer_load_dwordx4 v2, s[36:39], s79 offen   lds
    s_add_u32 s79, s77, 7168
    buffer_load_dwordx4 v2, s[36:39], s79 offen offset:1024  lds
    buffer_load_dwordx4 v[152:155], v13, s[48:51], s76 offen sc1
    buffer_load_dwordx4 v[156:159], v17, s[48:51], s76 offen sc1
    s_waitcnt vmcnt(23)
    ds_read_b64_tr_b16 v[32:33], v3 offset:10240
    ds_read_b64_tr_b16 v[34:35], v3 offset:10752
    ds_read_b64_tr_b16 v[36:37], v4 offset:10240
    ds_read_b64_tr_b16 v[38:39], v4 offset:10752
    s_waitcnt lgkmcnt(4)
    s_add_u32 s75, s63, 12
    s_and_b32 s75, s75, 15
    s_lshr_b32 s64, s75, 2
    s_min_u32 s64, s64, 2
    s_lshl2_add_u32 s75, s64, s75
    s_lshl_b32 s76, s75, 10
    s_add_u32 s76, s76, s66
    s_lshl_b32 s77, s75, 14
    s_add_u32 s77, s77, s22
    v_mfma_f32_32x32x16_bf16 v[48:63], v[24:27], v[160:163], v[48:63]
    v_mfma_f32_32x32x16_bf16 v[64:79], v[24:27], v[164:167], v[64:79]
    v_mfma_f32_32x32x16_bf16 v[96:111], v[28:31], v[160:163], v[96:111]
    v_mfma_f32_32x32x16_bf16 v[112:127], v[28:31], v[164:167], v[112:127]
    s_add_u32 m0, s28, 8192
    s_add_u32 s79, s77, 0
    buffer_load_dwordx4 v2, s[36:39], s79 offen   lds
    s_add_u32 s79, s77, 7168
    buffer_load_dwordx4 v2, s[36:39], s79 offen offset:1024  lds
    buffer_load_dwordx4 v[160:163], v13, s[48:51], s76 offen sc1
    buffer_load_dwordx4 v[164:167], v17, s[48:51], s76 offen sc1
    s_waitcnt vmcnt(25)
    ds_read_b64_tr_b16 v[24:25], v3 offset:12288
    ds_read_b64_tr_b16 v[26:27], v3 offset:12800
    ds_read_b64_tr_b16 v[28:29], v4 offset:12288
    ds_read_b64_tr_b16 v[30:31], v4 offset:12800
    s_waitcnt lgkmcnt(4)
    s_add_u32 s75, s63, 13
    s_and_b32 s75, s75, 15
    s_lshr_b32 s64, s75, 2
    s_min_u32 s64, s64, 2
    s_lshl2_add_u32 s75, s64, s75
    s_lshl_b32 s76, s75, 10
    s_add_u32 s76, s76, s66
    s_lshl_b32 s77, s75, 14
    s_add_u32 s77, s77, s22
    v_mfma_f32_32x32x16_bf16 v[48:63], v[32:35], v[168:171], v[48:63]
    v_mfma_f32_32x32x16_bf16 v[64:79], v[32:35], v[172:175], v[64:79]
    v_mfma_f32_32x32x16_bf16 v[96:111], v[36:39], v[168:171], v[96:111]
    v_mfma_f32_32x32x16_bf16 v[112:127], v[36:39], v[172:175], v[112:127]
    s_add_u32 m0, s28, 10240
    s_add_u32 s79, s77, 0
    buffer_load_dwordx4 v2, s[36:39], s79 offen   lds
    s_add_u32 s79, s77, 7168
    buffer_load_dwordx4 v2, s[36:39], s79 offen offset:1024  lds
    buffer_load_dwordx4 v[168:171], v13, s[48:51], s76 offen sc1
    buffer_load_dwordx4 v[172:175], v17, s[48:51], s76 offen sc1
    s_waitcnt vmcnt(27)
    ds_read_b64_tr_b16 v[32:33], v3 offset:14336
    ds_read_b64_tr_b16 v[34:35], v3 offset:14848
    ds_read_b64_tr_b16 v[36:37], v4 offset:14336
    ds_read_b64_tr_b16 v[38:39], v4 offset:14848
    s_waitcnt lgkmcnt(4)
    s_add_u32 s75, s63, 14
    s_and_b32 s75, s75, 15
    s_lshr_b32 s64, s75, 2
    s_min_u32 s64, s64, 2
    s_lshl2_add_u32 s75, s64, s75
    s_lshl_b32 s76, s75, 10
    s_add_u32 s76, s76, s66
    s_lshl_b32 s77, s75, 14
    s_add_u32 s77, s77, s22
    v_mfma_f32_32x32x16_bf16 v[48:63], v[24:27], v[176:179], v[48:63]
    v_mfma_f32_32x32x16_bf16 v[64:79], v[24:27], v[180:183], v[64:79]
    v_mfma_f32_32x32x16_bf16 v[96:111], v[28:31], v[176:179], v[96:111]
    v_mfma_f32_32x32x16_bf16 v[112:127], v[28:31], v[180:183], v[112:127]
    s_add_u32 m0, s28, 12288
    s_add_u32 s79, s77, 0
    buffer_load_dwordx4 v2, s[36:39], s79 offen   lds
    s_add_u32 s79, s77, 7168
    buffer_load_dwordx4 v2, s[36:39], s79 offen offset:1024  lds
    buffer_load_dwordx4 v[176:179], v13, s[48:51], s76 offen sc1
    buffer_load_dwordx4 v[180:183], v17, s[48:51], s76 offen sc1
    s_waitcnt vmcnt(26)
    ds_read_b64_tr_b16 v[24:25], v3 offset:0
    ds_read_b64_tr_b16 v[26:27], v3 offset:512
    ds_read_b64_tr_b16 v[28:29], v4 offset:0
    ds_read_b64_tr_b16 v[30:31], v4 offset:512
    s_waitcnt lgkmcnt(4)
    s_add_u32 s75, s63, 15
    s_and_b32 s75, s75, 15
    s_lshr_b32 s64, s75, 2
    s_min_u32 s64, s64, 2
    s_lshl2_add_u32 s75, s64, s75
    s_lshl_b32 s76, s75, 10
    s_add_u32 s76, s76, s66
    s_lshl_b32 s77, s75, 14
    s_add_u32 s77, s77, s22
    v_mfma_f32_32x32x16_bf16 v[48:63], v[32:35], v[184:187], v[48:63]
    v_mfma_f32_32x32x16_bf16 v[64:79], v[32:35], v[188:191], v[64:79]
    v_mfma_f32_32x32x16_bf16 v[96:111], v[36:39], v[184:187], v[96:111]
    v_mfma_f32_32x32x16_bf16 v[112:127], v[36:39], v[188:191], v[112:127]
    s_add_u32 m0, s28, 14336
    s_add_u32 s79, s77, 0
    buffer_load_dwordx4 v2, s[36:39], s79 offen   lds
    s_add_u32 s79, s77, 7168
    buffer_load_dwordx4 v2, s[36:39], s79 offen offset:1024  lds
    buffer_load_dwordx4 v[184:187], v13, s[48:51], s76 offen sc1
    buffer_load_dwordx4 v[188:191], v17, s[48:51], s76 offen sc1
    s_load_dword s4, s[20:21], 262144 glc
    s_load_dword s5, s[20:21], 262272 glc
    s_load_dword s6, s[20:21], 262400 glc
    s_load_dword s7, s[20:21], 262528 glc
    s_load_dword s8, s[20:21], 266240 glc
    s_load_dword s9, s[20:21], 266368 glc
    s_load_dword s10, s[20:21], 266496 glc
    s_load_dword s11, s[20:21], 266624 glc
    s_waitcnt vmcnt(26)
    ds_read_b64_tr_b16 v[32:33], v3 offset:2048
    ds_read_b64_tr_b16 v[34:35], v3 offset:2560
    ds_read_b64_tr_b16 v[36:37], v4 offset:2048
    ds_read_b64_tr_b16 v[38:39], v4 offset:2560
    s_waitcnt lgkmcnt(4)
    s_add_u32 s75, s3, 0
    s_sub_u32 s64, s75, 12
    s_cmp_ge_u32 s75, 12
    s_cselect_b32 s75, s64, s75
    s_lshr_b32 s64, s75, 2
    s_lshl_b32 s64, 4, s64
    s_add_u32 s75, s75, s64
    s_lshl_b32 s76, s75, 10
    s_add_u32 s76, s76, s66
    s_lshl_b32 s77, s75, 14
    s_add_u32 s77, s77, s22
    v_mfma_f32_32x32x16_bf16 v[48:63], v[24:27], v[128:131], v[48:63]
    v_mfma_f32_32x32x16_bf16 v[64:79], v[24:27], v[132:135], v[64:79]
    v_mfma_f32_32x32x16_bf16 v[96:111], v[28:31], v[128:131], v[96:111]
    v_mfma_f32_32x32x16_bf16 v[112:127], v[28:31], v[132:135], v[112:127]
    s_add_u32 m0, s28, 0
    s_add_u32 s79, s77, 0
    buffer_load_dwordx4 v2, s[36:39], s79 offen   lds
    s_add_u32 s79, s77, 7168
    buffer_load_dwordx4 v2, s[36:39], s79 offen offset:1024  lds
    s_waitcnt lgkmcnt(0)
    s_xor_b32 s4, s4, s80
    s_xor_b32 s5, s5, s80
    s_or_b32 s4, s4, s5
    s_xor_b32 s6, s6, s80
    s_or_b32 s4, s4, s6
    s_xor_b32 s7, s7, s80
    s_or_b32 s4, s4, s7
    s_xor_b32 s8, s8, s80
    s_or_b32 s4, s4, s8
    s_xor_b32 s9, s9, s80
    s_or_b32 s4, s4, s9
    s_xor_b32 s10, s10, s80
    s_or_b32 s4, s4, s10
    s_xor_b32 s11, s11, s80
    s_or_b32 s4, s4, s11
    s_cbranch_scc1 L_hb_sl_300
L_hb_ok_299:
    buffer_load_dwordx4 v[128:131], v13, s[48:51], s76 offen sc1
    buffer_load_dwordx4 v[132:135], v17, s[48:51], s76 offen sc1
    s_waitcnt vmcnt(26)
    ds_read_b64_tr_b16 v[24:25], v3 offset:4096
    ds_read_b64_tr_b16 v[26:27], v3 offset:4608
    ds_read_b64_tr_b16 v[28:29], v4 offset:4096
    ds_read_b64_tr_b16 v[30:31], v4 offset:4608
    s_waitcnt lgkmcnt(4)
    s_add_u32 s75, s3, 1
    s_sub_u32 s64, s75, 12
    s_cmp_ge_u32 s75, 12
    s_cselect_b32 s75, s64, s75
    s_lshr_b32 s64, s75, 2
    s_lshl_b32 s64, 4, s64
    s_add_u32 s75, s75, s64
    s_lshl_b32 s76, s75, 10
    s_add_u32 s76, s76, s66
    s_lshl_b32 s77, s75, 14
    s_add_u32 s77, s77, s22
    v_mfma_f32_32x32x16_bf16 v[48:63], v[32:35], v[136:139], v[48:63]
    v_mfma_f32_32x32x16_bf16 v[64:79], v[32:35], v[140:143], v[64:79]
    v_mfma_f32_32x32x16_bf16 v[96:111], v[36:39], v[136:139], v[96:111]
    v_mfma_f32_32x32x16_bf16 v[112:127], v[36:39], v[140:143], v[112:127]
    s_add_u32 m0, s28, 2048
    s_add_u32 s79, s77, 0
    buffer_load_dwordx4 v2, s[36:39], s79 offen   lds
    s_add_u32 s79, s77, 7168
    buffer_load_dwordx4 v2, s[36:39], s79 offen offset:1024  lds
    buffer_load_dwordx4 v[136:139], v13, s[48:51], s76 offen sc1
    buffer_load_dwordx4 v[140:143], v17, s[48:51], s76 offen sc1
    s_waitcnt vmcnt(26)
    ds_read_b64_tr_b16 v[32:33], v3 offset:6144
    ds_read_b64_tr_b16 v[34:35], v3 offset:6656
    ds_read_b64_tr_b16 v[36:37], v4 offset:6144
    ds_read_b64_tr_b16 v[38:39], v4 offset:6656
    s_waitcnt lgkmcnt(4)
    s_add_u32 s75, s3, 2
    s_sub_u32 s64, s75, 12
    s_cmp_ge_u32 s75, 12
    s_cselect_b32 s75, s64, s75
    s_lshr_b32 s64, s75, 2
    s_lshl_b32 s64, 4, s64
    s_add_u32 s75, s75, s64
    s_lshl_b32 s76, s75, 10
    s_add_u32 s76, s76, s66
    s_lshl_b32 s77, s75, 14
    s_add_u32 s77, s77, s22
    v_mfma_f32_32x32x16_bf16 v[48:63], v[24:27], v[144:147], v[48:63]
    v_mfma_f32_32x32x16_bf16 v[64:79], v[24:27], v[148:151], v[64:79]
    v_mfma_f32_32x32x16_bf16 v[96:111], v[28:31], v[144:147], v[96:111]
    v_mfma_f32_32x32x16_bf16 v[112:127], v[28:31], v[148:151], v[112:127]
    s_add_u32 m0, s28, 4096
    s_add_u32 s79, s77, 0
    buffer_load_dwordx4 v2, s[36:39], s79 offen   lds
    s_add_u32 s79, s77, 7168
    buffer_load_dwordx4 v2, s[36:39], s79 offen offset:1024  lds
    buffer_load_dwordx4 v[144:147], v13, s[48:51], s76 offen sc1
    buffer_load_dwordx4 v[148:151], v17, s[48:51], s76 offen sc1
    s_waitcnt vmcnt(26)
    ds_read_b64_tr_b16 v[24:25], v3 offset:8192
    ds_read_b64_tr_b16 v[26:27], v3 offset:8704
    ds_read_b64_tr_b16 v[28:29], v4 offset:8192
    ds_read_b64_tr_b16 v[30:31], v4 offset:8704
    s_waitcnt lgkmcnt(4)
    s_add_u32 s75, s3, 3
    s_sub_u32 s64, s75, 12
    s_cmp_ge_u32 s75, 12
    s_cselect_b32 s75, s64, s75
    s_lshr_b32 s64, s75, 2
    s_lshl_b32 s64, 4, s64
    s_add_u32 s75, s75, s64
    s_lshl_b32 s76, s75, 10
    s_add_u32 s76, s76, s66
    s_lshl_b32 s77, s75, 14
    s_add_u32 s77, s77, s22
    v_mfma_f32_32x32x16_bf16 v[48:63], v[32:35], v[152:155], v[48:63]
    v_mfma_f32_32x32x16_bf16 v[64:79], v[32:35], v[156:159], v[64:79]
    v_mfma_f32_32x32x16_bf16 v[96:111], v[36:39], v[152:155], v[96:111]
    v_mfma_f32_32x32x16_bf16 v[112:127], v[36:39], v[156:159], v[112:127]
    s_add_u32 m0, s28, 6144
    s_add_u32 s79, s77, 0
    buffer_load_dwordx4 v2, s[36:39], s79 offen   lds
    s_add_u32 s79, s77, 7168
    buffer_load_dwordx4 v2, s[36:39], s79 offen offset:1024  lds
    buffer_load_dwordx4 v[152:155], v13, s[48:51], s76 offen sc1
    buffer_load_dwordx4 v[156:159], v17, s[48:51], s76 offen sc1
    s_waitcnt vmcnt(26)
    ds_read_b64_tr_b16 v[32:33], v3 offset:10240
    ds_read_b64_tr_b16 v[34:35], v3 offset:10752
    ds_read_b64_tr_b16 v[36:37], v4 offset:10240
    ds_read_b64_tr_b16 v[38:39], v4 offset:10752
    s_waitcnt lgkmcnt(4)
    s_add_u32 s75, s3, 4
    s_sub_u32 s64, s75, 12
    s_cmp_ge_u32 s75, 12
    s_cselect_b32 s75, s64, s75
    s_lshr_b32 s64, s75, 2
    s_lshl_b32 s64, 4, s64
    s_add_u32 s75, s75, s64
    s_lshl_b32 s76, s75, 10
    s_add_u32 s76, s76, s66
    s_lshl_b32 s77, s75, 14
    s_add_u32 s77, s77, s22
    v_mfma_f32_32x32x16_bf16 v[48:63], v[24:27], v[160:163], v[48:63]
    v_mfma_f32_32x32x16_bf16 v[64:79], v[24:27], v[164:167], v[64:79]
    v_mfma_f32_32x32x16_bf16 v[96:111], v[28:31], v[160:163], v[96:111]
    v_mfma_f32_32x32x16_bf16 v[112:127], v[28:31], v[164:167], v[112:127]
    s_add_u32 m0, s28, 8192
    s_add_u32 s79, s77, 0
    buffer_load_dwordx4 v2, s[36:39], s79 offen   lds
    s_add_u32 s79, s77, 7168
    buffer_load_dwordx4 v2, s[36:39], s79 offen offset:1024  lds
    buffer_load_dwordx4 v[160:163], v13, s[48:51], s76 offen sc1
    buffer_load_dwordx4 v[164:167], v17, s[48:51], s76 offen sc1
    s_waitcnt vmcnt(26)
    ds_read_b64_tr_b16 v[24:25], v3 offset:12288
    ds_read_b64_tr_b16 v[26:27], v3 offset:12800
    ds_read_b64_tr_b16 v[28:29], v4 offset:12288
    ds_read_b64_tr_b16 v[30:31], v4 offset:12800
    s_waitcnt lgkmcnt(4)
    s_add_u32 s75, s3, 5
    s_sub_u32 s64, s75, 12
    s_cmp_ge_u32 s75, 12
    s_cselect_b32 s75, s64, s75
    s_lshr_b32 s64, s75, 2
    s_lshl_b32 s64, 4, s64
    s_add_u32 s75, s75, s64
    s_lshl_b32 s76, s75, 10
    s_add_u32 s76, s76, s66
    s_lshl_b32 s77, s75, 14
    s_add_u32 s77, s77, s22
    v_mfma_f32_32x32x16_bf16 v[48:63], v[32:35], v[168:171], v[48:63]
    v_mfma_f32_32x32x16_bf16 v[64:79], v[32:35], v[172:175], v[64:79]
    v_mfma_f32_32x32x16_bf16 v[96:111], v[36:39], v[168:171], v[96:111]
    v_mfma_f32_32x32x16_bf16 v[112:127], v[36:39], v[172:175], v[112:127]
    s_add_u32 m0, s28, 10240
    s_add_u32 s79, s77, 0
    buffer_load_dwordx4 v2, s[36:39], s79 offen   lds
    s_add_u32 s79, s77, 7168
    buffer_load_dwordx4 v2, s[36:39], s79 offen offset:1024  lds
    buffer_load_dwordx4 v[168:171], v13, s[48:51], s76 offen sc1
    buffer_load_dwordx4 v[172:175], v17, s[48:51], s76 offen sc1
    s_waitcnt vmcnt(26)
    ds_read_b64_tr_b16 v[32:33], v3 offset:14336
    ds_read_b64_tr_b16 v[34:35], v3 offset:14848
    ds_read_b64_tr_b16 v[36:37], v4 offset:14336
    ds_read_b64_tr_b16 v[38:39], v4 offset:14848
    s_waitcnt lgkmcnt(4)
    s_add_u32 s75, s3, 6
    s_sub_u32 s64, s75, 12
    s_cmp_ge_u32 s75, 12
    s_cselect_b32 s75, s64, s75
    s_lshr_b32 s64, s75, 2
    s_lshl_b32 s64, 4, s64
    s_add_u32 s75, s75, s64
    s_lshl_b32 s76, s75, 10
    s_add_u32 s76, s76, s66
    s_lshl_b32 s77, s75, 14
    s_add_u32 s77, s77, s22
    v_mfma_f32_32x32x16_bf16 v[48:63], v[24:27], v[176:179], v[48:63]
    v_mfma_f32_32x32x16_bf16 v[64:79], v[24:27], v[180:183], v[64:79]
    v_mfma_f32_32x32x16_bf16 v[96:111], v[28:31], v[176:179], v[96:111]
    v_mfma_f32_32x32x16_bf16 v[112:127], v[28:31], v[180:183], v[112:127]
    s_add_u32 m0, s28, 12288
    s_add_u32 s79, s77, 0
    buffer_load_dwordx4 v2, s[36:39], s79 offen   lds
    s_add_u32 s79, s77, 7168
    buffer_load_dwordx4 v2, s[36:39], s79 offen offset:1024  lds
    buffer_load_dwordx4 v[176:179], v13, s[48:51], s76 offen sc1
    buffer_load_dwordx4 v[180:183], v17, s[48:51], s76 offen sc1
    s_waitcnt vmcnt(26)
    ds_read_b64_tr_b16 v[24:25], v3 offset:0
    ds_read_b64_tr_b16 v[26:27], v3 offset:512
    ds_read_b64_tr_b16 v[28:29], v4 offset:0
    ds_read_b64_tr_b16 v[30:31], v4 offset:512
    s_waitcnt lgkmcnt(4)
    s_add_u32 s75, s3, 7
    s_sub_u32 s64, s75, 12
    s_cmp_ge_u32 s75, 12
    s_cselect_b32 s75, s64, s75
    s_lshr_b32 s64, s75, 2
    s_lshl_b32 s64, 4, s64
    s_add_u32 s75, s75, s64
    s_lshl_b32 s76, s75, 10
    s_add_u32 s76, s76, s66
    s_lshl_b32 s77, s75, 14
    s_add_u32 s77, s77, s22
    v_mfma_f32_32x32x16_bf16 v[48:63], v[32:35], v[184:187], v[48:63]
    v_mfma_f32_32x32x16_bf16 v[64:79], v[32:35], v[188:191], v[64:79]
    v_mfma_f32_32x32x16_bf16 v[96:111], v[36:39], v[184:187], v[96:111]
    v_mfma_f32_32x32x16_bf16 v[112:127], v[36:39], v[188:191], v[112:127]
    s_add_u32 m0, s28, 14336
    s_add_u32 s79, s77, 0
    buffer_load_dwordx4 v2, s[36:39], s79 offen   lds
    s_add_u32 s79, s77, 7168
    buffer_load_dwordx4 v2, s[36:39], s79 offen offset:1024  lds
    buffer_load_dwordx4 v[184:187], v13, s[48:51], s76 offen sc1
    buffer_load_dwordx4 v[188:191], v17, s[48:51], s76 offen sc1
    s_waitcnt vmcnt(26)
    ds_read_b64_tr_b16 v[32:33], v3 offset:2048
    ds_read_b64_tr_b16 v[34:35], v3 offset:2560
    ds_read_b64_tr_b16 v[36:37], v4 offset:2048
    ds_read_b64_tr_b16 v[38:39], v4 offset:2560
    s_waitcnt lgkmcnt(4)
    s_add_u32 s75, s3, 8
    s_sub_u32 s64, s75, 12
    s_cmp_ge_u32 s75, 12
    s_cselect_b32 s75, s64, s75
    s_lshr_b32 s64, s75, 2
    s_lshl_b32 s64, 4, s64
    s_add_u32 s75, s75, s64
    s_lshl_b32 s76, s75, 10
    s_add_u32 s76, s76, s66
    s_lshl_b32 s77, s75, 14
    s_add_u32 s77, s77, s22
    v_mfma_f32_32x32x16_bf16 v[48:63], v[24:27], v[128:131], v[48:63]
    v_mfma_f32_32x32x16_bf16 v[64:79], v[24:27], v[132:135], v[64:79]
    v_mfma_f32_32x32x16_bf16 v[96:111], v[28:31], v[128:131], v[96:111]
    v_mfma_f32_32x32x16_bf16 v[112:127], v[28:31], v[132:135], v[112:127]
    s_add_u32 m0, s28, 0
    s_add_u32 s79, s77, 0
    buffer_load_dwordx4 v2, s[36:39], s79 offen   lds
    s_add_u32 s79, s77, 7168
    buffer_load_dwordx4 v2, s[36:39], s79 offen offset:1024  lds
    buffer_load_dwordx4 v[128:131], v13, s[48:51], s76 offen sc1
    buffer_load_dwordx4 v[132:135], v17, s[48:51], s76 offen sc1
    s_waitcnt vmcnt(26)
    ds_read_b64_tr_b16 v[24:25], v3 offset:4096
    ds_read_b64_tr_b16 v[26:27], v3 offset:4608
    ds_read_b64_tr_b16 v[28:29], v4 offset:4096
    ds_read_b64_tr_b16 v[30:31], v4 offset:4608
    s_waitcnt lgkmcnt(4)
    s_add_u32 s75, s3, 9
    s_sub_u32 s64, s75, 12
    s_cmp_ge_u32 s75, 12
    s_cselect_b32 s75, s64, s75
    s_lshr_b32 s64, s75, 2
    s_lshl_b32 s64, 4, s64
    s_add_u32 s75, s75, s64
    s_lshl_b32 s76, s75, 10
    s_add_u32 s76, s76, s66
    s_lshl_b32 s77, s75, 14
    s_add_u32 s77, s77, s22
    v_mfma_f32_32x32x16_bf16 v[48:63], v[32:35], v[136:139], v[48:63]
    v_mfma_f32_32x32x16_bf16 v[64:79], v[32:35], v[140:143], v[64:79]
    v_mfma_f32_32x32x16_bf16 v[96:111], v[36:39], v[136:139], v[96:111]
    v_mfma_f32_32x32x16_bf16 v[112:127], v[36:39], v[140:143], v[112:127]
    s_add_u32 m0, s28, 2048
    s_add_u32 s79, s77, 0
    buffer_load_dwordx4 v2, s[36:39], s79 offen   lds
    s_add_u32 s79, s77, 7168
    buffer_load_dwordx4 v2, s[36:39], s79 offen offset:1024  lds
    buffer_load_dwordx4 v[136:139], v13, s[48:51], s76 offen sc1
    buffer_load_dwordx4 v[140:143], v17, s[48:51], s76 offen sc1
    s_waitcnt vmcnt(26)
    ds_read_b64_tr_b16 v[32:33], v3 offset:6144
    ds_read_b64_tr_b16 v[34:35], v3 offset:6656
    ds_read_b64_tr_b16 v[36:37], v4 offset:6144
    ds_read_b64_tr_b16 v[38:39], v4 offset:6656
    s_waitcnt lgkmcnt(4)
    s_add_u32 s75, s3, 10
    s_sub_u32 s64, s75, 12
    s_cmp_ge_u32 s75, 12
    s_cselect_b32 s75, s64, s75
    s_lshr_b32 s64, s75, 2
    s_lshl_b32 s64, 4, s64
    s_add_u32 s75, s75, s64
    s_lshl_b32 s76, s75, 10
    s_add_u32 s76, s76, s66
    s_lshl_b32 s77, s75, 14
    s_add_u32 s77, s77, s22
    v_mfma_f32_32x32x16_bf16 v[48:63], v[24:27], v[144:147], v[48:63]
    v_mfma_f32_32x32x16_bf16 v[64:79], v[24:27], v[148:151], v[64:79]
    v_mfma_f32_32x32x16_bf16 v[96:111], v[28:31], v[144:147], v[96:111]
    v_mfma_f32_32x32x16_bf16 v[112:127], v[28:31], v[148:151], v[112:127]
    s_add_u32 m0, s28, 4096
    s_add_u32 s79, s77, 0
    buffer_load_dwordx4 v2, s[36:39], s79 offen   lds
    s_add_u32 s79, s77, 7168
    buffer_load_dwordx4 v2, s[36:39], s79 offen offset:1024  lds
    buffer_load_dwordx4 v[144:147], v13, s[48:51], s76 offen sc1
    buffer_load_dwordx4 v[148:151], v17, s[48:51], s76 offen sc1
    s_waitcnt vmcnt(26)
    ds_read_b64_tr_b16 v[24:25], v3 offset:8192
    ds_read_b64_tr_b16 v[26:27], v3 offset:8704
    ds_read_b64_tr_b16 v[28:29], v4 offset:8192
    ds_read_b64_tr_b16 v[30:31], v4 offset:8704
    s_waitcnt lgkmcnt(4)
    s_add_u32 s75, s3, 11
    s_sub_u32 s64, s75, 12
    s_cmp_ge_u32 s75, 12
    s_cselect_b32 s75, s64, s75
    s_lshr_b32 s64, s75, 2
    s_lshl_b32 s64, 4, s64
    s_add_u32 s75, s75, s64
    s_lshl_b32 s76, s75, 10
    s_add_u32 s76, s76, s66
    s_lshl_b32 s77, s75, 14
    s_add_u32 s77, s77, s22
    v_mfma_f32_32x32x16_bf16 v[48:63], v[32:35], v[152:155], v[48:63]
    v_mfma_f32_32x32x16_bf16 v[64:79], v[32:35], v[156:159], v[64:79]
    v_mfma_f32_32x32x16_bf16 v[96:111], v[36:39], v[152:155], v[96:111]
    v_mfma_f32_32x32x16_bf16 v[112:127], v[36:39], v[156:159], v[112:127]
    s_add_u32 m0, s28, 6144
    s_add_u32 s79, s77, 0
    buffer_load_dwordx4 v2, s[36:39], s79 offen   lds
    s_add_u32 s79, s77, 7168
    buffer_load_dwordx4 v2, s[36:39], s79 offen offset:1024  lds
    buffer_load_dwordx4 v[152:155], v13, s[48:51], s76 offen sc1
    buffer_load_dwordx4 v[156:159], v17, s[48:51], s76 offen sc1
    s_lshl_b32 s64, s62, 9
    s_add_u32 s20, s20, s64
    s_addc_u32 s21, s21, 0
    s_load_dword s4, s[20:21], 524288 glc
    s_load_dword s5, s[20:21], 524416 glc
    s_load_dword s6, s[20:21], 524544 glc
    s_load_dword s7, s[20:21], 524672 glc
    s_load_dword s8, s[20:21], 524800 glc
    s_load_dword s9, s[20:21], 524928 glc
    s_load_dword s10, s[20:21], 525056 glc
    s_load_dword s11, s[20:21], 525184 glc
    s_load_dword s12, s[20:21], 528384 glc
    s_load_dword s13, s[20:21], 528512 glc
    s_load_dword s14, s[20:21], 528640 glc
    s_load_dword s15, s[20:21], 528768 glc
    s_load_dword s16, s[20:21], 528896 glc
    s_load_dword s17, s[20:21], 529024 glc
    s_load_dword s18, s[20:21], 529152 glc
    s_load_dword s19, s[20:21], 529280 glc
    s_waitcnt vmcnt(26)
    ds_read_b64_tr_b16 v[32:33], v3 offset:10240
    ds_read_b64_tr_b16 v[34:35], v3 offset:10752
    ds_read_b64_tr_b16 v[36:37], v4 offset:10240
    ds_read_b64_tr_b16 v[38:39], v4 offset:10752
    s_waitcnt lgkmcnt(4)
    s_add_u32 s76, s67, 0
    s_add_u32 s77, s23, 0
    v_mfma_f32_32x32x16_bf16 v[48:63], v[24:27], v[160:163], v[48:63]
    v_mfma_f32_32x32x16_bf16 v[64:79], v[24:27], v[164:167], v[64:79]
    v_mfma_f32_32x32x16_bf16 v[96:111], v[28:31], v[160:163], v[96:111]
    v_mfma_f32_32x32x16_bf16 v[112:127], v[28:31], v[164:167], v[112:127]
    s_add_u32 m0, s28, 8192
    s_add_u32 s79, s77, 0
    buffer_load_dwordx4 v2, s[40:43], s79 offen   lds
    s_add_u32 s79, s77, 7168
    buffer_load_dwordx4 v2, s[40:43], s79 offen offset:1024  lds
    s_waitcnt lgkmcnt(0)
    s_xor_b32 s4, s4, s80
    s_xor_b32 s5, s5, s80
    s_or_b32 s4, s4, s5
    s_xor_b32 s6, s6, s80
    s_or_b32 s4, s4, s6
    s_xor_b32 s7, s7, s80
    s_or_b32 s4, s4, s7
    s_xor_b32 s8, s8, s80
    s_or_b32 s4, s4, s8
    s_xor_b32 s9, s9, s80
    s_or_b32 s4, s4, s9
    s_xor_b32 s10, s10, s80
    s_or_b32 s4, s4, s10
    s_xor_b32 s11, s11, s80
    s_or_b32 s4, s4, s11
    s_xor_b32 s12, s12, s80
    s_or_b32 s4, s4, s12
    s_xor_b32 s13, s13, s80
    s_or_b32 s4, s4, s13
    s_xor_b32 s14, s14, s80
    s_or_b32 s4, s4, s14
    s_xor_b32 s15, s15, s80
    s_or_b32 s4, s4, s15
    s_xor_b32 s16, s16, s80
    s_or_b32 s4, s4, s16
    s_xor_b32 s17, s17, s80
    s_or_b32 s4, s4, s17
    s_xor_b32 s18, s18, s80
    s_or_b32 s4, s4, s18
    s_xor_b32 s19, s19, s80
    s_or_b32 s4, s4, s19
    s_cbranch_scc1 L_o_sl_304
L_o_ok_303:
    buffer_load_dwordx4 v[160:163], v13, s[48:51], s76 offen sc1
    buffer_load_dwordx4 v[164:167], v17, s[48:51], s76 offen sc1
    s_waitcnt vmcnt(26)
    ds_read_b64_tr_b16 v[24:25], v3 offset:12288
    ds_read_b64_tr_b16 v[26:27], v3 offset:12800
    ds_read_b64_tr_b16 v[28:29], v4 offset:12288
    ds_read_b64_tr_b16 v[30:31], v4 offset:12800
    s_waitcnt lgkmcnt(4)
    s_add_u32 s76, s67, 1024
    s_add_u32 s77, s23, 16384
    v_mfma_f32_32x32x16_bf16 v[48:63], v[32:35], v[168:171], v[48:63]
    v_mfma_f32_32x32x16_bf16 v[64:79], v[32:35], v[172:175], v[64:79]
    v_mfma_f32_32x32x16_bf16 v[96:111], v[36:39], v[168:171], v[96:111]
    v_mfma_f32_32x32x16_bf16 v[112:127], v[36:39], v[172:175], v[112:127]
    s_add_u32 m0, s28, 10240
    s_add_u32 s79, s77, 0
    buffer_load_dwordx4 v2, s[40:43], s79 offen   lds
    s_add_u32 s79, s77, 7168
    buffer_load_dwordx4 v2, s[40:43], s79 offen offset:1024  lds
    buffer_load_dwordx4 v[168:171], v13, s[48:51], s76 offen sc1
    buffer_load_dwordx4 v[172:175], v17, s[48:51], s76 offen sc1
    s_waitcnt vmcnt(26)
    ds_read_b64_tr_b16 v[32:33], v3 offset:14336
    ds_read_b64_tr_b16 v[34:35], v3 offset:14848
    ds_read_b64_tr_b16 v[36:37], v4 offset:14336
    ds_read_b64_tr_b16 v[38:39], v4 offset:14848
    s_waitcnt lgkmcnt(4)
    s_add_u32 s76, s67, 2048
    s_add_u32 s77, s23, 32768
    v_mfma_f32_32x32x16_bf16 v[48:63], v[24:27], v[176:179], v[48:63]
    v_mfma_f32_32x32x16_bf16 v[64:79], v[24:27], v[180:183], v[64:79]
    v_mfma_f32_32x32x16_bf16 v[96:111], v[28:31], v[176:179], v[96:111]
    v_mfma_f32_32x32x16_bf16 v[112:127], v[28:31], v[180:183], v[112:127]
    s_add_u32 m0, s28, 12288
    s_add_u32 s79, s77, 0
    buffer_load_dwordx4 v2, s[40:43], s79 offen   lds
    s_add_u32 s79, s77, 7168
    buffer_load_dwordx4 v2, s[40:43], s79 offen offset:1024  lds
    buffer_load_dwordx4 v[176:179], v13, s[48:51], s76 offen sc1
    buffer_load_dwordx4 v[180:183], v17, s[48:51], s76 offen sc1
    s_waitcnt vmcnt(26)
    ds_read_b64_tr_b16 v[24:25], v3 offset:0
    ds_read_b64_tr_b16 v[26:27], v3 offset:512
    ds_read_b64_tr_b16 v[28:29], v4 offset:0
    ds_read_b64_tr_b16 v[30:31], v4 offset:512
    s_waitcnt lgkmcnt(4)
    s_add_u32 s76, s67, 3072
    s_add_u32 s77, s23, 49152
    v_mfma_f32_32x32x16_bf16 v[48:63], v[32:35], v[184:187], v[48:63]
    v_mfma_f32_32x32x16_bf16 v[64:79], v[32:35], v[188:191], v[64:79]
    v_mfma_f32_32x32x16_bf16 v[96:111], v[36:39], v[184:187], v[96:111]
    v_mfma_f32_32x32x16_bf16 v[112:127], v[36:39], v[188:191], v[112:127]
    s_add_u32 m0, s28, 14336
    s_add_u32 s79, s77, 0
    buffer_load_dwordx4 v2, s[40:43], s79 offen   lds
    s_add_u32 s79, s77, 7168
    buffer_load_dwordx4 v2, s[40:43], s79 offen offset:1024  lds
    buffer_load_dwordx4 v[184:187], v13, s[48:51], s76 offen sc1
    buffer_load_dwordx4 v[188:191], v17, s[48:51], s76 offen sc1
    s_waitcnt vmcnt(26)
    ds_read_b64_tr_b16 v[32:33], v3 offset:2048
    ds_read_b64_tr_b16 v[34:35], v3 offset:2560
    ds_read_b64_tr_b16 v[36:37], v4 offset:2048
    ds_read_b64_tr_b16 v[38:39], v4 offset:2560
    s_waitcnt lgkmcnt(4)
    s_add_u32 s76, s67, 4096
    s_add_u32 s77, s23, 65536
    v_mfma_f32_32x32x16_bf16 v[48:63], v[24:27], v[128:131], v[48:63]
    v_mfma_f32_32x32x16_bf16 v[64:79], v[24:27], v[132:135], v[64:79]
    v_mfma_f32_32x32x16_bf16 v[96:111], v[28:31], v[128:131], v[96:111]
    v_mfma_f32_32x32x16_bf16 v[112:127], v[28:31], v[132:135], v[112:127]
    s_add_u32 m0, s28, 0
    s_add_u32 s79, s77, 0
    buffer_load_dwordx4 v2, s[40:43], s79 offen   lds
    s_add_u32 s79, s77, 7168
    buffer_load_dwordx4 v2, s[40:43], s79 offen offset:1024  lds
    buffer_load_dwordx4 v[128:131], v13, s[48:51], s76 offen sc1
    buffer_load_dwordx4 v[132:135], v17, s[48:51], s76 offen sc1
    s_waitcnt vmcnt(26)
    ds_read_b64_tr_b16 v[24:25], v3 offset:4096
    ds_read_b64_tr_b16 v[26:27], v3 offset:4608
    ds_read_b64_tr_b16 v[28:29], v4 offset:4096
    ds_read_b64_tr_b16 v[30:31], v4 offset:4608
    s_waitcnt lgkmcnt(4)
    s_add_u32 s76, s67, 5120
    s_add_u32 s77, s23, 81920
    v_mfma_f32_32x32x16_bf16 v[48:63], v[32:35], v[136:139], v[48:63]
    v_mfma_f32_32x32x16_bf16 v[64:79], v[32:35], v[140:143], v[64:79]
    v_mfma_f32_32x32x16_bf16 v[96:111], v[36:39], v[136:139], v[96:111]
    v_mfma_f32_32x32x16_bf16 v[112:127], v[36:39], v[140:143], v[112:127]
    s_add_u32 m0, s28, 2048
    s_add_u32 s79, s77, 0
    buffer_load_dwordx4 v2, s[40:43], s79 offen   lds
    s_add_u32 s79, s77, 7168
    buffer_load_dwordx4 v2, s[40:43], s79 offen offset:1024  lds
    buffer_load_dwordx4 v[136:139], v13, s[48:51], s76 offen sc1
    buffer_load_dwordx4 v[140:143], v17, s[48:51], s76 offen sc1
    s_waitcnt vmcnt(26)
    ds_read_b64_tr_b16 v[32:33], v3 offset:6144
    ds_read_b64_tr_b16 v[34:35], v3 offset:6656
    ds_read_b64_tr_b16 v[36:37], v4 offset:6144
    ds_read_b64_tr_b16 v[38:39], v4 offset:6656
    s_waitcnt lgkmcnt(4)
    s_add_u32 s76, s67, 6144
    s_add_u32 s77, s23, 98304
    v_mfma_f32_32x32x16_bf16 v[48:63], v[24:27], v[144:147], v[48:63]
    v_mfma_f32_32x32x16_bf16 v[64:79], v[24:27], v[148:151], v[64:79]
    v_mfma_f32_32x32x16_bf16 v[96:111], v[28:31], v[144:147], v[96:111]
    v_mfma_f32_32x32x16_bf16 v[112:127], v[28:31], v[148:151], v[112:127]
    s_add_u32 m0, s28, 4096
    s_add_u32 s79, s77, 0
    buffer_load_dwordx4 v2, s[40:43], s79 offen   lds
    s_add_u32 s79, s77, 7168
    buffer_load_dwordx4 v2, s[40:43], s79 offen offset:1024  lds
    buffer_load_dwordx4 v[144:147], v13, s[48:51], s76 offen sc1
    buffer_load_dwordx4 v[148:151], v17, s[48:51], s76 offen sc1
    s_waitcnt vmcnt(26)
    ds_read_b64_tr_b16 v[24:25], v3 offset:8192
    ds_read_b64_tr_b16 v[26:27], v3 offset:8704
    ds_read_b64_tr_b16 v[28:29], v4 offset:8192
    ds_read_b64_tr_b16 v[30:31], v4 offset:8704
    s_waitcnt lgkmcnt(4)
    s_add_u32 s76, s67, 7168
    s_add_u32 s77, s23, 114688
    v_mfma_f32_32x32x16_bf16 v[48:63], v[32:35], v[152:155], v[48:63]
    v_mfma_f32_32x32x16_bf16 v[64:79], v[32:35], v[156:159], v[64:79]
    v_mfma_f32_32x32x16_bf16 v[96:111], v[36:39], v[152:155], v[96:111]
    v_mfma_f32_32x32x16_bf16 v[112:127], v[36:39], v[156:159], v[112:127]
    s_add_u32 m0, s28, 6144
    s_add_u32 s79, s77, 0
    buffer_load_dwordx4 v2, s[40:43], s79 offen   lds
    s_add_u32 s79, s77, 7168
    buffer_load_dwordx4 v2, s[40:43], s79 offen offset:1024  lds
    buffer_load_dwordx4 v[152:155], v13, s[48:51], s76 offen sc1
    buffer_load_dwordx4 v[156:159], v17, s[48:51], s76 offen sc1
    s_waitcnt vmcnt(26)
    ds_read_b64_tr_b16 v[32:33], v3 offset:10240
    ds_read_b64_tr_b16 v[34:35], v3 offset:10752
    ds_read_b64_tr_b16 v[36:37], v4 offset:10240
    ds_read_b64_tr_b16 v[38:39], v4 offset:10752
    s_waitcnt lgkmcnt(4)
    v_mfma_f32_32x32x16_bf16 v[48:63], v[24:27], v[160:163], v[48:63]
    v_mfma_f32_32x32x16_bf16 v[64:79], v[24:27], v[164:167], v[64:79]
    v_mfma_f32_32x32x16_bf16 v[96:111], v[28:31], v[160:163], v[96:111]
    v_mfma_f32_32x32x16_bf16 v[112:127], v[28:31], v[164:167], v[112:127]
    s_waitcnt vmcnt(22)
    ds_read_b64_tr_b16 v[24:25], v3 offset:12288
    ds_read_b64_tr_b16 v[26:27], v3 offset:12800
    ds_read_b64_tr_b16 v[28:29], v4 offset:12288
    ds_read_b64_tr_b16 v[30:31], v4 offset:12800
    s_waitcnt lgkmcnt(4)
    v_mfma_f32_32x32x16_bf16 v[48:63], v[32:35], v[168:171], v[48:63]
    v_mfma_f32_32x32x16_bf16 v[64:79], v[32:35], v[172:175], v[64:79]
    v_mfma_f32_32x32x16_bf16 v[96:111], v[36:39], v[168:171], v[96:111]
    v_mfma_f32_32x32x16_bf16 v[112:127], v[36:39], v[172:175], v[112:127]
    s_waitcnt vmcnt(18)
    ds_read_b64_tr_b16 v[32:33], v3 offset:14336
    ds_read_b64_tr_b16 v[34:35], v3 offset:14848
    ds_read_b64_tr_b16 v[36:37], v4 offset:14336
    ds_read_b64_tr_b16 v[38:39], v4 offset:14848
    s_waitcnt lgkmcnt(4)
    v_mfma_f32_32x32x16_bf16 v[48:63], v[24:27], v[176:179], v[48:63]
    v_mfma_f32_32x32x16_bf16 v[64:79], v[24:27], v[180:183], v[64:79]
    v_mfma_f32_32x32x16_bf16 v[96:111], v[28:31], v[176:179], v[96:111]
    v_mfma_f32_32x32x16_bf16 v[112:127], v[28:31], v[180:183], v[112:127]
    s_waitcnt vmcnt(14)
    ds_read_b64_tr_b16 v[24:25], v3 offset:0
    ds_read_b64_tr_b16 v[26:27], v3 offset:512
    ds_read_b64_tr_b16 v[28:29], v4 offset:0
    ds_read_b64_tr_b16 v[30:31], v4 offset:512
    s_waitcnt lgkmcnt(4)
    v_mfma_f32_32x32x16_bf16 v[48:63], v[32:35], v[184:187], v[48:63]
    v_mfma_f32_32x32x16_bf16 v[64:79], v[32:35], v[188:191], v[64:79]
    v_mfma_f32_32x32x16_bf16 v[96:111], v[36:39], v[184:187], v[96:111]
    v_mfma_f32_32x32x16_bf16 v[112:127], v[36:39], v[188:191], v[112:127]
    s_waitcnt vmcnt(10)
    ds_read_b64_tr_b16 v[32:33], v3 offset:2048
    ds_read_b64_tr_b16 v[34:35], v3 offset:2560
    ds_read_b64_tr_b16 v[36:37], v4 offset:2048
    ds_read_b64_tr_b16 v[38:39], v4 offset:2560
    s_waitcnt lgkmcnt(4)
    v_mfma_f32_32x32x16_bf16 v[48:63], v[24:27], v[128:131], v[48:63]
    v_mfma_f32_32x32x16_bf16 v[64:79], v[24:27], v[132:135], v[64:79]
    v_mfma_f32_32x32x16_bf16 v[96:111], v[28:31], v[128:131], v[96:111]
    v_mfma_f32_32x32x16_bf16 v[112:127], v[28:31], v[132:135], v[112:127]
    s_waitcnt vmcnt(6)
    ds_read_b64_tr_b16 v[24:25], v3 offset:4096
    ds_read_b64_tr_b16 v[26:27], v3 offset:4608
    ds_read_b64_tr_b16 v[28:29], v4 offset:4096
    ds_read_b64_tr_b16 v[30:31], v4 offset:4608
    s_waitcnt lgkmcnt(4)
    v_mfma_f32_32x32x16_bf16 v[48:63], v[32:35], v[136:139], v[48:63]
    v_mfma_f32_32x32x16_bf16 v[64:79], v[32:35], v[140:143], v[64:79]
    v_mfma_f32_32x32x16_bf16 v[96:111], v[36:39], v[136:139], v[96:111]
    v_mfma_f32_32x32x16_bf16 v[112:127], v[36:39], v[140:143], v[112:127]
    s_waitcnt vmcnt(2)
    ds_read_b64_tr_b16 v[32:33], v3 offset:6144
    ds_read_b64_tr_b16 v[34:35], v3 offset:6656
    ds_read_b64_tr_b16 v[36:37], v4 offset:6144
    ds_read_b64_tr_b16 v[38:39], v4 offset:6656
    s_waitcnt lgkmcnt(4)
    v_mfma_f32_32x32x16_bf16 v[48:63], v[24:27], v[144:147], v[48:63]
    v_mfma_f32_32x32x16_bf16 v[64:79], v[24:27], v[148:151], v[64:79]
    v_mfma_f32_32x32x16_bf16 v[96:111], v[28:31], v[144:147], v[96:111]
    v_mfma_f32_32x32x16_bf16 v[112:127], v[28:31], v[148:151], v[112:127]
    s_waitcnt vmcnt(0)
    s_waitcnt lgkmcnt(0)
    v_mfma_f32_32x32x16_bf16 v[48:63], v[32:35], v[152:155], v[48:63]
    v_mfma_f32_32x32x16_bf16 v[64:79], v[32:35], v[156:159], v[64:79]
    v_mfma_f32_32x32x16_bf16 v[96:111], v[36:39], v[152:155], v[96:111]
    v_mfma_f32_32x32x16_bf16 v[112:127], v[36:39], v[156:159], v[112:127]
    v_add_u32 v18, s28, v13
    s_nop 9
    s_cmp_eq_u32 s62, 0
    s_cbranch_scc1 L_rw_307
    ds_write_b128 v18, v[48:51] offset:0
    ds_write_b128 v18, v[52:55] offset:1024
    ds_write_b128 v18, v[56:59] offset:2048
    ds_write_b128 v18, v[60:63] offset:3072
L_re_308:
    s_cmp_eq_u32 s62, 1
    s_cbranch_scc1 L_rw_309
    ds_write_b128 v18, v[64:67] offset:4096
    ds_write_b128 v18, v[68:71] offset:5120
    ds_write_b128 v18, v[72:75] offset:6144
    ds_write_b128 v18, v[76:79] offset:7168
L_re_310:
    s_cmp_eq_u32 s62, 2
    s_cbranch_scc1 L_rw_311
    ds_write_b128 v18, v[96:99] offset:8192
    ds_write_b128 v18, v[100:103] offset:9216
    ds_write_b128 v18, v[104:107] offset:10240
    ds_write_b128 v18, v[108:111] offset:11264
L_re_312:
    s_cmp_eq_u32 s62, 3
    s_cbranch_scc1 L_rw_313
    ds_write_b128 v18, v[112:115] offset:12288
    ds_write_b128 v18, v[116:119] offset:13312
    ds_write_b128 v18, v[120:123] offset:14336
    ds_write_b128 v18, v[124:127] offset:15360
L_re_314:
    s_lshl_b32 s64, s62, 12
    v_add_u32 v18, s64, v18
    v_xor_b32 v19, 65536, v18
    v_xor_b32 v24, 0xc000, v18
    v_xor_b32 v25, 114688, v18
    v_lshrrev_b32 v26, 5, v0
    s_and_b32 s64, s62, 2
    v_lshl_add_u32 v26, v26, 1, s64
    v_add_u32 v26, s64, v26
    v_and_b32 v27, 7, v0
    v_xor_b32 v26, v26, v27
    v_lshlrev_b32 v26, 4, v26
    v_and_b32 v27, 31, v0
    v_lshl_add_u32 v26, v27, 7, v26
    s_and_b32 s64, s62, 1
    s_lshl_b32 s64, s64, 12
    s_add_u32 s64, s64, 131072
    v_add_u32 v26, s64, v26
    v_xor_b32 v27, 16, v26
    s_waitcnt lgkmcnt(0)
    s_barrier
    ds_read_b128 v[192:195], v26
    ds_read_b128 v[196:199], v27
    ds_read_b128 v[128:131], v19 offset:0
    ds_read_b128 v[132:135], v19 offset:1024
    ds_read_b128 v[136:139], v19 offset:2048
    ds_read_b128 v[140:143], v19 offset:3072
    ds_read_b128 v[144:147], v24 offset:0
    ds_read_b128 v[148:151], v24 offset:1024
    ds_read_b128 v[152:155], v24 offset:2048
    ds_read_b128 v[156:159], v24 offset:3072
    ds_read_b128 v[160:163], v25 offset:0
    ds_read_b128 v[164:167], v25 offset:1024
    ds_read_b128 v[168:171], v25 offset:2048
    ds_read_b128 v[172:175], v25 offset:3072
    s_waitcnt lgkmcnt(12)
    v_lshlrev_b32 v176, 16, v192
    v_and_b32 v177, 0xffff0000, v192
    v_lshlrev_b32 v178, 16, v193
    v_and_b32 v179, 0xffff0000, v193
    v_lshlrev_b32 v180, 16, v194
    v_and_b32 v181, 0xffff0000, v194
    v_lshlrev_b32 v182, 16, v195
    v_and_b32 v183, 0xffff0000, v195
    v_lshlrev_b32 v184, 16, v196
    v_and_b32 v185, 0xffff0000, v196
    v_lshlrev_b32 v186, 16, v197
    v_and_b32 v187, 0xffff0000, v197
    v_lshlrev_b32 v188, 16, v198
    v_and_b32 v189, 0xffff0000, v198
    v_lshlrev_b32 v190, 16, v199
    v_and_b32 v191, 0xffff0000, v199
    v_add_f32 v200, v200, v176
    v_add_f32 v201, v201, v177
    v_add_f32 v202, v202, v178
    v_add_f32 v203, v203, v179
    v_add_f32 v204, v204, v180
    v_add_f32 v205, v205, v181
    v_add_f32 v206, v206, v182
    v_add_f32 v207, v207, v183
    v_add_f32 v208, v208, v184
    v_add_f32 v209, v209, v185
    v_add_f32 v210, v210, v186
    v_add_f32 v211, v211, v187
    v_add_f32 v212, v212, v188
    v_add_f32 v213, v213, v189
    v_add_f32 v214, v214, v190
    v_add_f32 v215, v215, v191
    s_waitcnt lgkmcnt(8)
    v_add_f32 v200, v200, v128
    v_add_f32 v201, v201, v129
    v_add_f32 v202, v202, v130
    v_add_f32 v203, v203, v131
    v_add_f32 v204, v204, v132
    v_add_f32 v205, v205, v133
    v_add_f32 v206, v206, v134
    v_add_f32 v207, v207, v135
    v_add_f32 v208, v208, v136
    v_add_f32 v209, v209, v137
    v_add_f32 v210, v210, v138
    v_add_f32 v211, v211, v139
    v_add_f32 v212, v212, v140
    v_add_f32 v213, v213, v141
    v_add_f32 v214, v214, v142
    v_add_f32 v215, v215, v143
    s_waitcnt lgkmcnt(4)
    v_add_f32 v200, v200, v144
    v_add_f32 v201, v201, v145
    v_add_f32 v202, v202, v146
    v_add_f32 v203, v203, v147
    v_add_f32 v204, v204, v148
    v_add_f32 v205, v205, v149
    v_add_f32 v206, v206, v150
    v_add_f32 v207, v207, v151
    v_add_f32 v208, v208, v152
    v_add_f32 v209, v209, v153
    v_add_f32 v210, v210, v154
    v_add_f32 v211, v211, v155
    v_add_f32 v212, v212, v156
    v_add_f32 v213, v213, v157
    v_add_f32 v214, v214, v158
    v_add_f32 v215, v215, v159
    s_waitcnt lgkmcnt(0)
    v_add_f32 v200, v200, v160
    v_add_f32 v201, v201, v161
    v_add_f32 v202, v202, v162
    v_add_f32 v203, v203, v163
    v_add_f32 v204, v204, v164
    v_add_f32 v205, v205, v165
    v_add_f32 v206, v206, v166
    v_add_f32 v207, v207, v167
    v_add_f32 v208, v208, v168
    v_add_f32 v209, v209, v169
    v_add_f32 v210, v210, v170
    v_add_f32 v211, v211, v171
    v_add_f32 v212, v212, v172
    v_add_f32 v213, v213, v173
    v_add_f32 v214, v214, v174
    v_add_f32 v215, v215, v175
    v_cvt_pk_bf16_f32 v200, v200, v201
    v_cvt_pk_bf16_f32 v201, v202, v203
    v_cvt_pk_bf16_f32 v202, v204, v205
    v_cvt_pk_bf16_f32 v203, v206, v207
    v_cvt_pk_bf16_f32 v204, v208, v209
    v_cvt_pk_bf16_f32 v205, v210, v211
    v_cvt_pk_bf16_f32 v206, v212, v213
    v_cvt_pk_bf16_f32 v207, v214, v215
    buffer_store_dwordx4 v[200:203], v10, s[44:47], 0 offen
    buffer_store_dwordx4 v[204:207], v10, s[44:47], 0 offen offset:16
    s_endpgm
L_rs_225:
    s_add_u32 s82, s82, 1
    s_cmp_gt_u32 s82, 60000
    s_cbranch_scc1 L_rsx_227
    buffer_load_dwordx4 v[108:111], v12, s[48:51], s22 offen sc1
    s_waitcnt vmcnt(0)
    s_branch L_rsr_226
L_pub_228:
    s_waitcnt vmcnt(0)
    v_mov_b32 v18, s80
    v_mov_b32 v19, s81
    s_mov_b64 exec, 1
    buffer_store_dwordx2 v[18:19], v15, s[48:51], s72 offen sc1
    s_mov_b64 exec, -1
    s_mov_b32 s77, 1
    s_branch L_pubr_229
L_pub_230:
    s_waitcnt vmcnt(0)
    v_mov_b32 v18, s80
    v_mov_b32 v19, s81
    s_mov_b64 exec, 1
    buffer_store_dwordx2 v[18:19], v15, s[48:51], s72 offen sc1
    s_mov_b64 exec, -1
    s_mov_b32 s77, 1
    s_branch L_pubr_231
L_pub_232:
    s_waitcnt vmcnt(0)
    v_mov_b32 v18, s80
    v_mov_b32 v19, s81
    s_mov_b64 exec, 1
    buffer_store_dwordx2 v[18:19], v15, s[48:51], s72 offen sc1
    s_mov_b64 exec, -1
    s_mov_b32 s77, 1
    s_branch L_pubr_233
L_pub_234:
    s_waitcnt vmcnt(0)
    v_mov_b32 v18, s80
    v_mov_b32 v19, s81
    s_mov_b64 exec, 1
    buffer_store_dwordx2 v[18:19], v15, s[48:51], s72 offen sc1
    s_mov_b64 exec, -1
    s_mov_b32 s77, 1
    s_branch L_pubr_235
L_pub_236:
    s_waitcnt vmcnt(0)
    v_mov_b32 v18, s80
    v_mov_b32 v19, s81
    s_mov_b64 exec, 1
    buffer_store_dwordx2 v[18:19], v15, s[48:51], s72 offen sc1
    s_mov_b64 exec, -1
    s_mov_b32 s77, 1
    s_branch L_pubr_237
L_pub_238:
    s_waitcnt vmcnt(0)
    v_mov_b32 v18, s80
    v_mov_b32 v19, s81
    s_mov_b64 exec, 1
    buffer_store_dwordx2 v[18:19], v15, s[48:51], s72 offen sc1
    s_mov_b64 exec, -1
    s_mov_b32 s77, 1
    s_branch L_pubr_239
L_pub_240:
    s_waitcnt vmcnt(0)
    v_mov_b32 v18, s80
    v_mov_b32 v19, s81
    s_mov_b64 exec, 1
    buffer_store_dwordx2 v[18:19], v15, s[48:51], s72 offen sc1
    s_mov_b64 exec, -1
    s_mov_b32 s77, 1
    s_branch L_pubr_241
L_pub_242:
    s_waitcnt vmcnt(0)
    v_mov_b32 v18, s80
    v_mov_b32 v19, s81
    s_mov_b64 exec, 1
    buffer_store_dwordx2 v[18:19], v15, s[48:51], s72 offen sc1
    s_mov_b64 exec, -1
    s_mov_b32 s77, 1
    s_branch L_pubr_243
L_pub_244:
    s_waitcnt vmcnt(0)
    v_mov_b32 v18, s80
    v_mov_b32 v19, s81
    s_mov_b64 exec, 1
    buffer_store_dwordx2 v[18:19], v15, s[48:51], s72 offen sc1
    s_mov_b64 exec, -1
    s_mov_b32 s77, 1
    s_branch L_pubr_245
L_pub_246:
    s_waitcnt vmcnt(0)
    v_mov_b32 v18, s80
    v_mov_b32 v19, s81
    s_mov_b64 exec, 1
    buffer_store_dwordx2 v[18:19], v15, s[48:51], s72 offen sc1
    s_mov_b64 exec, -1
    s_mov_b32 s77, 1
    s_branch L_pubr_247
L_pub_248:
    s_waitcnt vmcnt(0)
    v_mov_b32 v18, s80
    v_mov_b32 v19, s81
    s_mov_b64 exec, 1
    buffer_store_dwordx2 v[18:19], v15, s[48:51], s72 offen sc1
    s_mov_b64 exec, -1
    s_mov_b32 s77, 1
    s_branch L_pubr_249
L_pub_250:
    s_waitcnt vmcnt(0)
    v_mov_b32 v18, s80
    v_mov_b32 v19, s81
    s_mov_b64 exec, 1
    buffer_store_dwordx2 v[18:19], v15, s[48:51], s72 offen sc1
    s_mov_b64 exec, -1
    s_mov_b32 s77, 1
    s_branch L_pubr_251
L_pub_258:
    s_waitcnt vmcnt(0)
    v_mov_b32 v18, s80
    v_mov_b32 v19, s81
    s_mov_b64 exec, 1
    buffer_store_dwordx2 v[18:19], v15, s[48:51], s78 offen sc1
    s_mov_b64 exec, -1
    s_mov_b32 s77, 1
    s_branch L_pubr_259
L_pub_260:
    s_waitcnt vmcnt(0)
    v_mov_b32 v18, s80
    v_mov_b32 v19, s81
    s_mov_b64 exec, 1
    buffer_store_dwordx2 v[18:19], v15, s[48:51], s78 offen sc1
    s_mov_b64 exec, -1
    s_mov_b32 s77, 1
    s_branch L_pubr_261
L_pub_262:
    s_waitcnt vmcnt(0)
    v_mov_b32 v18, s80
    v_mov_b32 v19, s81
    s_mov_b64 exec, 1
    buffer_store_dwordx2 v[18:19], v15, s[48:51], s78 offen sc1
    s_mov_b64 exec, -1
    s_mov_b32 s77, 1
    s_branch L_pubr_263
L_pub_264:
    s_waitcnt vmcnt(0)
    v_mov_b32 v18, s80
    v_mov_b32 v19, s81
    s_mov_b64 exec, 1
    buffer_store_dwordx2 v[18:19], v15, s[48:51], s78 offen sc1
    s_mov_b64 exec, -1
    s_mov_b32 s77, 1
    s_branch L_pubr_265
L_pub_266:
    s_waitcnt vmcnt(0)
    v_mov_b32 v18, s80
    v_mov_b32 v19, s81
    s_mov_b64 exec, 1
    buffer_store_dwordx2 v[18:19], v15, s[48:51], s78 offen sc1
    s_mov_b64 exec, -1
    s_mov_b32 s77, 1
    s_branch L_pubr_267
L_pub_268:
    s_waitcnt vmcnt(0)
    v_mov_b32 v18, s80
    v_mov_b32 v19, s81
    s_mov_b64 exec, 1
    buffer_store_dwordx2 v[18:19], v15, s[48:51], s78 offen sc1
    s_mov_b64 exec, -1
    s_mov_b32 s77, 1
    s_branch L_pubr_269
L_pub_270:
    s_waitcnt vmcnt(0)
    v_mov_b32 v18, s80
    v_mov_b32 v19, s81
    s_mov_b64 exec, 1
    buffer_store_dwordx2 v[18:19], v15, s[48:51], s78 offen sc1
    s_mov_b64 exec, -1
    s_mov_b32 s77, 1
    s_branch L_pubr_271
L_pub_272:
    s_waitcnt vmcnt(0)
    v_mov_b32 v18, s80
    v_mov_b32 v19, s81
    s_mov_b64 exec, 1
    buffer_store_dwordx2 v[18:19], v15, s[48:51], s78 offen sc1
    s_mov_b64 exec, -1
    s_mov_b32 s77, 1
    s_branch L_pubr_273
L_pub_274:
    s_waitcnt vmcnt(0)
    v_mov_b32 v18, s80
    v_mov_b32 v19, s81
    s_mov_b64 exec, 1
    buffer_store_dwordx2 v[18:19], v15, s[48:51], s78 offen sc1
    s_mov_b64 exec, -1
    s_mov_b32 s77, 1
    s_branch L_pubr_275
L_pub_276:
    s_waitcnt vmcnt(0)
    v_mov_b32 v18, s80
    v_mov_b32 v19, s81
    s_mov_b64 exec, 1
    buffer_store_dwordx2 v[18:19], v15, s[48:51], s78 offen sc1
    s_mov_b64 exec, -1
    s_mov_b32 s77, 1
    s_branch L_pubr_277
L_pub_280:
    s_waitcnt vmcnt(0)
    v_mov_b32 v18, s80
    v_mov_b32 v19, s81
    s_mov_b64 exec, 1
    buffer_store_dwordx2 v[18:19], v15, s[48:51], s78 offen sc1
    s_mov_b64 exec, -1
    s_mov_b32 s77, 1
    s_branch L_pubr_281
L_pub_282:
    s_waitcnt vmcnt(0)
    v_mov_b32 v18, s80
    v_mov_b32 v19, s81
    s_mov_b64 exec, 1
    buffer_store_dwordx2 v[18:19], v15, s[48:51], s78 offen sc1
    s_mov_b64 exec, -1
    s_mov_b32 s77, 1
    s_branch L_pubr_283
L_pub_284:
    s_waitcnt vmcnt(0)
    v_mov_b32 v18, s80
    v_mov_b32 v19, s81
    s_mov_b64 exec, 1
    buffer_store_dwordx2 v[18:19], v15, s[48:51], s78 offen sc1
    s_mov_b64 exec, -1
    s_mov_b32 s77, 1
    s_branch L_pubr_285
L_pub_286:
    s_waitcnt vmcnt(0)
    v_mov_b32 v18, s80
    v_mov_b32 v19, s81
    s_mov_b64 exec, 1
    buffer_store_dwordx2 v[18:19], v15, s[48:51], s78 offen sc1
    s_mov_b64 exec, -1
    s_mov_b32 s77, 1
    s_branch L_pubr_287
L_pub_288:
    s_waitcnt vmcnt(0)
    v_mov_b32 v18, s80
    v_mov_b32 v19, s81
    s_mov_b64 exec, 1
    buffer_store_dwordx2 v[18:19], v15, s[48:51], s78 offen sc1
    s_mov_b64 exec, -1
    s_mov_b32 s77, 1
    s_branch L_pubr_289
L_pub_290:
    s_waitcnt vmcnt(0)
    v_mov_b32 v18, s80
    v_mov_b32 v19, s81
    s_mov_b64 exec, 1
    buffer_store_dwordx2 v[18:19], v15, s[48:51], s78 offen sc1
    s_mov_b64 exec, -1
    s_mov_b32 s77, 1
    s_branch L_pubr_291
L_hasl_293:
    s_waitcnt vmcnt(0)
    v_mov_b32 v18, s80
    v_mov_b32 v19, s81
    s_mov_b64 exec, 1
    buffer_store_dwordx2 v[18:19], v15, s[48:51], s78 offen sc1
    s_mov_b64 exec, -1
    s_mov_b32 s82, 0
L_ha_p_295:
    s_load_dword s4, s[20:21], 0 glc
    s_load_dword s5, s[20:21], 128 glc
    s_load_dword s6, s[20:21], 256 glc
    s_load_dword s7, s[20:21], 384 glc
    s_load_dword s8, s[20:21], 4096 glc
    s_load_dword s9, s[20:21], 4224 glc
    s_load_dword s10, s[20:21], 4352 glc
    s_load_dword s11, s[20:21], 4480 glc
    s_add_u32 s82, s82, 1
    s_waitcnt lgkmcnt(0)
    s_xor_b32 s4, s4, s80
    s_xor_b32 s5, s5, s80
    s_or_b32 s4, s4, s5
    s_xor_b32 s6, s6, s80
    s_or_b32 s4, s4, s6
    s_xor_b32 s7, s7, s80
    s_or_b32 s4, s4, s7
    s_xor_b32 s8, s8, s80
    s_or_b32 s4, s4, s8
    s_xor_b32 s9, s9, s80
    s_or_b32 s4, s4, s9
    s_xor_b32 s10, s10, s80
    s_or_b32 s4, s4, s10
    s_xor_b32 s11, s11, s80
    s_or_b32 s4, s4, s11
    s_cbranch_scc0 L_ha_d_296
    s_cmp_gt_u32 s82, 60000
    s_cbranch_scc1 L_ha_d_296
    s_sleep 8
    s_branch L_ha_p_295
L_ha_d_296:
    s_branch L_haok_294
L_hb_sl_300:
    s_mov_b32 s82, 0
L_hb_p_301:
    s_load_dword s4, s[20:21], 262144 glc
    s_load_dword s5, s[20:21], 262272 glc
    s_load_dword s6, s[20:21], 262400 glc
    s_load_dword s7, s[20:21], 262528 glc
    s_load_dword s8, s[20:21], 266240 glc
    s_load_dword s9, s[20:21], 266368 glc
    s_load_dword s10, s[20:21], 266496 glc
    s_load_dword s11, s[20:21], 266624 glc
    s_add_u32 s82, s82, 1
    s_waitcnt lgkmcnt(0)
    s_xor_b32 s4, s4, s80
    s_xor_b32 s5, s5, s80
    s_or_b32 s4, s4, s5
    s_xor_b32 s6, s6, s80
    s_or_b32 s4, s4, s6
    s_xor_b32 s7, s7, s80
    s_or_b32 s4, s4, s7
    s_xor_b32 s8, s8, s80
    s_or_b32 s4, s4, s8
    s_xor_b32 s9, s9, s80
    s_or_b32 s4, s4, s9
    s_xor_b32 s10, s10, s80
    s_or_b32 s4, s4, s10
    s_xor_b32 s11, s11, s80
    s_or_b32 s4, s4, s11
    s_cbranch_scc0 L_hb_d_302
    s_cmp_gt_u32 s82, 60000
    s_cbranch_scc1 L_hb_d_302
    s_sleep 8
    s_branch L_hb_p_301
L_hb_d_302:
    s_branch L_hb_ok_299
L_o_sl_304:
    s_mov_b32 s82, 0
L_o_p_305:
    s_load_dword s4, s[20:21], 524288 glc
    s_load_dword s5, s[20:21], 524416 glc
    s_load_dword s6, s[20:21], 524544 glc
    s_load_dword s7, s[20:21], 524672 glc
    s_load_dword s8, s[20:21], 524800 glc
    s_load_dword s9, s[20:21], 524928 glc
    s_load_dword s10, s[20:21], 525056 glc
    s_load_dword s11, s[20:21], 525184 glc
    s_load_dword s12, s[20:21], 528384 glc
    s_load_dword s13, s[20:21], 528512 glc
    s_load_dword s14, s[20:21], 528640 glc
    s_load_dword s15, s[20:21], 528768 glc
    s_load_dword s16, s[20:21], 528896 glc
    s_load_dword s17, s[20:21], 529024 glc
    s_load_dword s18, s[20:21], 529152 glc
    s_load_dword s19, s[20:21], 529280 glc
    s_add_u32 s82, s82, 1
    s_waitcnt lgkmcnt(0)
    s_xor_b32 s4, s4, s80
    s_xor_b32 s5, s5, s80
    s_or_b32 s4, s4, s5
    s_xor_b32 s6, s6, s80
    s_or_b32 s4, s4, s6
    s_xor_b32 s7, s7, s80
    s_or_b32 s4, s4, s7
    s_xor_b32 s8, s8, s80
    s_or_b32 s4, s4, s8
    s_xor_b32 s9, s9, s80
    s_or_b32 s4, s4, s9
    s_xor_b32 s10, s10, s80
    s_or_b32 s4, s4, s10
    s_xor_b32 s11, s11, s80
    s_or_b32 s4, s4, s11
    s_xor_b32 s12, s12, s80
    s_or_b32 s4, s4, s12
    s_xor_b32 s13, s13, s80
    s_or_b32 s4, s4, s13
    s_xor_b32 s14, s14, s80
    s_or_b32 s4, s4, s14
    s_xor_b32 s15, s15, s80
    s_or_b32 s4, s4, s15
    s_xor_b32 s16, s16, s80
    s_or_b32 s4, s4, s16
    s_xor_b32 s17, s17, s80
    s_or_b32 s4, s4, s17
    s_xor_b32 s18, s18, s80
    s_or_b32 s4, s4, s18
    s_xor_b32 s19, s19, s80
    s_or_b32 s4, s4, s19
    s_cbranch_scc0 L_o_d_306
    s_cmp_gt_u32 s82, 60000
    s_cbranch_scc1 L_o_d_306
    s_sleep 8
    s_branch L_o_p_305
L_o_d_306:
    s_branch L_o_ok_303
L_rw_307:
    v_mov_b32 v200, v48
    v_mov_b32 v201, v49
    v_mov_b32 v202, v50
    v_mov_b32 v203, v51
    v_mov_b32 v204, v52
    v_mov_b32 v205, v53
    v_mov_b32 v206, v54
    v_mov_b32 v207, v55
    v_mov_b32 v208, v56
    v_mov_b32 v209, v57
    v_mov_b32 v210, v58
    v_mov_b32 v211, v59
    v_mov_b32 v212, v60
    v_mov_b32 v213, v61
    v_mov_b32 v214, v62
    v_mov_b32 v215, v63
    s_branch L_re_308
L_rw_309:
    v_mov_b32 v200, v64
    v_mov_b32 v201, v65
    v_mov_b32 v202, v66
    v_mov_b32 v203, v67
    v_mov_b32 v204, v68
    v_mov_b32 v205, v69
    v_mov_b32 v206, v70
    v_mov_b32 v207, v71
    v_mov_b32 v208, v72
    v_mov_b32 v209, v73
    v_mov_b32 v210, v74
    v_mov_b32 v211, v75
    v_mov_b32 v212, v76
    v_mov_b32 v213, v77
    v_mov_b32 v214, v78
    v_mov_b32 v215, v79
    s_branch L_re_310
L_rw_311:
    v_mov_b32 v200, v96
    v_mov_b32 v201, v97
    v_mov_b32 v202, v98
    v_mov_b32 v203, v99
    v_mov_b32 v204, v100
    v_mov_b32 v205, v101
    v_mov_b32 v206, v102
    v_mov_b32 v207, v103
    v_mov_b32 v208, v104
    v_mov_b32 v209, v105
    v_mov_b32 v210, v106
    v_mov_b32 v211, v107
    v_mov_b32 v212, v108
    v_mov_b32 v213, v109
    v_mov_b32 v214, v110
    v_mov_b32 v215, v111
    s_branch L_re_312
L_rw_313:
    v_mov_b32 v200, v112
    v_mov_b32 v201, v113
    v_mov_b32 v202, v114
    v_mov_b32 v203, v115
    v_mov_b32 v204, v116
    v_mov_b32 v205, v117
    v_mov_b32 v206, v118
    v_mov_b32 v207, v119
    v_mov_b32 v208, v120
    v_mov_b32 v209, v121
    v_mov_b32 v210, v122
    v_mov_b32 v211, v123
    v_mov_b32 v212, v124
    v_mov_b32 v213, v125
    v_mov_b32 v214, v126
    v_mov_b32 v215, v127
    s_branch L_re_314
L_END:
    s_endpgm
.section .rodata,"a"
.p2align 6
.amdhsa_kernel parallel_sum__sliding_block__dense_activation_relu__prompt_kernel
  .amdhsa_next_free_vgpr 256
  .amdhsa_next_free_sgpr 102
  .amdhsa_accum_offset 256
  .amdhsa_group_segment_fixed_size 0
  .amdhsa_kernarg_size 72
  .amdhsa_user_sgpr_count 2
  .amdhsa_user_sgpr_kernarg_segment_ptr 1
  .amdhsa_system_sgpr_workgroup_id_x 1
.end_amdhsa_kernel
```
